```python
import torch

def _softmax(x, axis=-1):
    return torch.softmax(x, dim=axis)
def _gelu(x):
    return torch.nn.functional.gelu(x, approximate="tanh")
def _silu(x):
    return torch.nn.functional.silu(x)
def _sigmoid(x):
    return torch.sigmoid(x)
def _layernorm(x, axis=-1, eps=1e-5):
    m = x.mean(dim=axis, keepdim=True)
    v = x.var(dim=axis, keepdim=True, unbiased=False)
    return (x - m) / torch.sqrt(v + eps)
def _scatter_add(tgt, idx, src, axis=0):
    return tgt.clone().index_add_(axis, idx, src)
def _segment_sum(src, seg, n):
    out = torch.zeros((n,) + src.shape[1:], dtype=src.dtype)
    return out.index_add_(0, seg, src)
def _pad(x, pw):
    flat = tuple(v for pair in reversed(pw) for v in pair)
    return torch.nn.functional.pad(x, flat)

kernel_name = 'standalone__adm_resblock__diffusion'

def setup_inputs():

    _w = (lambda a: (lambda t: t.to(torch.bfloat16) if t.is_floating_point() else t)(torch.as_tensor(a)))
    B, C, HW, E = 2, 512, 64, 768
    sc = (9.0 * C) ** -0.5
    return {
        "x": _w((lambda *s: torch.randn(*s, dtype=torch.bfloat16) * 0.05)(B, C, HW, HW)),
        "t_emb": _w((lambda *s: torch.randn(*s, dtype=torch.bfloat16) * 0.2)(B, E)),
        "g1": _w(1.0 + 0.1 * (lambda *s: torch.randn(*s, dtype=torch.bfloat16) * 0.2)(C)),
        "be1": _w(0.1 * (lambda *s: torch.randn(*s, dtype=torch.bfloat16) * 0.2)(C)),
        "w1": _w((lambda *s: torch.randn(*s, dtype=torch.bfloat16) * 0.2)(C, C, 3, 3) * sc),
        "w_emb": _w((lambda *s: torch.randn(*s, dtype=torch.bfloat16) * 0.2)(E, C) * (E ** -0.5)),
        "g2": _w(1.0 + 0.1 * (lambda *s: torch.randn(*s, dtype=torch.bfloat16) * 0.2)(C)),
        "be2": _w(0.1 * (lambda *s: torch.randn(*s, dtype=torch.bfloat16) * 0.2)(C)),
        "w2": _w((lambda *s: torch.randn(*s, dtype=torch.bfloat16) * 0.2)(C, C, 3, 3) * sc),
    }

def reference(x, t_emb, g1, be1, w1, w_emb, g2, be2, w2):
    B, C, H, W = x.shape
    G, eps = 4, 1e-5
    def gn(z, gamma, beta):
        zr = z.reshape(B, G, (C // G) * H * W)
        mu = zr.mean(-1).reshape(B, G, 1)
        var = ((zr - mu) ** 2).mean(-1).reshape(B, G, 1)
        zn = ((zr - mu) / torch.sqrt(var + eps)).reshape(B, C, H, W)
        return zn * gamma.reshape(1, C, 1, 1) + beta.reshape(1, C, 1, 1)
    def conv3(z, w):
        zp = _pad(z, ((0, 0), (0, 0), (1, 1), (1, 1)))
        taps = [torch.einsum("bchw,oc->bohw", zp[:, :, i:i+H, j:j+W], w[:, :, i, j]) for i in range(3) for j in range(3)]
        out = taps[0]
        for t in taps[1:]:
            out = out + t
        return out
    h = conv3(_silu(gn(x, g1, be1)), w1)
    emb = _silu(t_emb) @ w_emb
    h = h + emb.reshape(B, C, 1, 1)
    h = conv3(_silu(gn(h, g2, be2)), w2)
    return x + h
```

```asm
; @launch grid=(256,1,1) block=(256,1,1) lds=149760
.amdgcn_target "amdgcn-amd-amdhsa--gfx950"
.text
.globl standalone__adm_resblock__diffusion_kernel
.p2align 8
.type standalone__adm_resblock__diffusion_kernel,@function
standalone__adm_resblock__diffusion_kernel:
    s_cmp_ge_u32 s2, 256
    s_cbranch_scc1 L_end
    s_load_dwordx16 s[32:47], s[0:1], 0
    s_load_dwordx8 s[48:55], s[0:1], 64
    s_memrealtime s[80:81]
    s_getpc_b64 s[82:83]
L_pc:
    v_lshlrev_b32 v8, 7, v0
    v_min_u32 v8, L_codeend-L_pc-4, v8
    global_load_dword v190, v8, s[82:83]
    v_lshrrev_b32 v1, 6, v0
    v_and_b32 v0, 63, v0
    v_mov_b32 v14, 0
    v_mov_b32 v12, 0
    v_readfirstlane_b32 s3, v1
    s_lshr_b32 s56, s2, 3
    s_and_b32 s56, s56, 12
    s_and_b32 s73, s2, 3
    s_add_u32 s56, s56, s73
    s_lshr_b32 s57, s2, 4
    s_and_b32 s57, s57, 8
    s_bfe_u32 s73, s2, 0x30002
    s_add_u32 s57, s57, s73
    s_lshr_b32 s58, s56, 3
    s_and_b32 s59, s56, 7
    s_lshl_b32 s59, s59, 3
    v_lshrrev_b32 v5, 5, v0
    v_and_b32 v6, 15, v0
    v_and_b32 v8, 31, v0
    v_lshlrev_b32 v7, 16, v5
    v_lshl_add_u32 v7, v8, 3, v7
    v_lshlrev_b32 v2, 4, v0
    s_lshl_b32 s67, s58, 22
    s_lshl_b32 s73, s57, 18
    s_add_u32 s67, s67, s73
    s_lshl_b32 s73, s59, 7
    s_add_u32 s67, s67, s73
    s_lshl_b32 s73, s3, 8
    s_add_u32 s67, s67, s73
    s_or_b32 s74, s2, s3
    s_waitcnt lgkmcnt(0)
    s_mov_b32 s24, s52
    s_and_b32 s25, s53, 0xffff
    s_mov_b32 s26, 0x100
    s_mov_b32 s27, 0x20000
    s_mov_b32 s16, s32
    s_and_b32 s17, s33, 0xffff
    s_mov_b32 s18, 0x800000
    s_mov_b32 s19, 0x20000
    s_cmp_lg_u32 s74, 3
    s_cbranch_scc1 L_noleader
    s_cmp_lg_u32 s2, 0
    s_cbranch_scc1 L_noleader
    s_or_b32 s80, s80, 1
    v_mov_b32 v8, s80
    s_mov_b64 exec, 1
    buffer_store_dword v8, v14, s[24:27], 0 offen sc0 sc1
    s_mov_b64 exec, -1
L_noleader:
    s_add_u32 s73, s67, 0
    buffer_load_dwordx2 v[16:17], v7, s[16:19], s73 offen
    s_add_u32 s73, s67, 8192
    buffer_load_dwordx2 v[18:19], v7, s[16:19], s73 offen
    s_add_u32 s73, s67, 16384
    buffer_load_dwordx2 v[20:21], v7, s[16:19], s73 offen
    s_add_u32 s73, s67, 24576
    buffer_load_dwordx2 v[22:23], v7, s[16:19], s73 offen
    s_add_u32 s73, s67, 32768
    buffer_load_dwordx2 v[24:25], v7, s[16:19], s73 offen
    s_add_u32 s73, s67, 40960
    buffer_load_dwordx2 v[26:27], v7, s[16:19], s73 offen
    s_add_u32 s73, s67, 49152
    buffer_load_dwordx2 v[28:29], v7, s[16:19], s73 offen
    s_add_u32 s73, s67, 57344
    buffer_load_dwordx2 v[30:31], v7, s[16:19], s73 offen
    s_add_u32 s73, s67, 131072
    buffer_load_dwordx2 v[32:33], v7, s[16:19], s73 offen
    s_add_u32 s73, s67, 139264
    buffer_load_dwordx2 v[34:35], v7, s[16:19], s73 offen
    s_add_u32 s73, s67, 147456
    buffer_load_dwordx2 v[36:37], v7, s[16:19], s73 offen
    s_add_u32 s73, s67, 155648
    buffer_load_dwordx2 v[38:39], v7, s[16:19], s73 offen
    s_add_u32 s73, s67, 163840
    buffer_load_dwordx2 v[40:41], v7, s[16:19], s73 offen
    s_add_u32 s73, s67, 172032
    buffer_load_dwordx2 v[42:43], v7, s[16:19], s73 offen
    s_add_u32 s73, s67, 180224
    buffer_load_dwordx2 v[44:45], v7, s[16:19], s73 offen
    s_add_u32 s73, s67, 188416
    buffer_load_dwordx2 v[46:47], v7, s[16:19], s73 offen
    s_and_b32 s72, s3, 1
    s_mul_i32 s95, s72, 9216
    s_add_u32 s95, s95, 131328
    s_lshl_b32 s74, s57, 1
    s_add_u32 s74, s74, s58
    s_mul_i32 s68, s74, 147456
    s_and_b32 s75, s56, 7
    s_mul_i32 s74, s75, 1152
    s_add_u32 s68, s68, s74
    s_mul_i32 s74, s72, 288
    s_add_u32 s68, s68, s74
    s_lshl_b32 s69, s57, 1
    s_add_u32 s69, s69, s72
    s_lshl_b32 s69, s69, 3
    s_add_u32 s69, s69, s75
    s_mul_i32 s69, s69, 36864
    s_lshl_b32 s72, s58, 10
    s_add_u32 s69, s69, s72
    s_add_u32 s69, s69, 0xe00000
    s_lshl_b32 s72, s56, 3
    s_lshl_b32 s73, s57, 8
    s_add_u32 s72, s72, s73
    s_add_u32 s72, s72, 4096
    v_writelane_b32 v12, s72, 1
    s_cmp_lt_u32 s3, 2
    s_cselect_b32 s87, 1, 0
    s_mov_b32 s20, s40
    s_and_b32 s21, s41, 0xffff
    s_mov_b32 s22, 0x480000
    s_mov_b32 s23, 0x20000
    s_mov_b32 s60, 0
    s_mov_b32 s66, 0
    s_mov_b32 s86, 0x1760000
    v_add_u32 v3, 4096, v2
    v_lshlrev_b32 v11, 4, v5
    v_bfe_u32 v8, v0, 4, 1
    v_lshlrev_b32 v4, 10, v8
    v_lshl_add_u32 v4, v5, 8, v4
    v_lshl_add_u32 v4, v6, 4, v4
    s_mov_b32 s4, s54
    s_and_b32 s5, s55, 0xffff
    s_mov_b32 s6, 0x3000000
    s_mov_b32 s7, 0x20000
    s_mov_b32 s8, s36
    s_and_b32 s9, s37, 0xffff
    s_mov_b32 s10, 0x400
    s_mov_b32 s11, 0x20000
    s_mov_b32 s12, s38
    s_and_b32 s13, s39, 0xffff
    s_mov_b32 s14, 0x400
    s_mov_b32 s15, 0x20000
    s_mov_b32 s28, s34
    s_and_b32 s29, s35, 0xffff
    s_mov_b32 s30, 0xc00
    s_mov_b32 s31, 0x20000
    s_lshl_b32 s72, s57, 6
    buffer_load_dwordx4 v[48:51], v11, s[8:11], s72 offen offset:0
    buffer_load_dwordx4 v[56:59], v11, s[12:15], s72 offen offset:0
    buffer_load_dwordx4 v[52:55], v11, s[8:11], s72 offen offset:32
    buffer_load_dwordx4 v[60:63], v11, s[12:15], s72 offen offset:32
    s_mul_i32 s79, s58, 6291456
    s_lshr_b32 s73, s57, 1
    s_mul_i32 s73, s73, 393216
    s_add_u32 s79, s79, s73
    s_lshl_b32 s73, s59, 10
    s_add_u32 s79, s79, s73
    s_lshl_b32 s73, s3, 11
    s_add_u32 s79, s79, s73
    s_and_b32 s73, s57, 1
    s_lshl_b32 s73, s73, 9
    s_add_u32 s79, s79, s73
    s_add_u32 s79, s79, s66
    s_lshl_b32 s78, s58, 2
    s_lshr_b32 s73, s57, 2
    s_add_u32 s78, s78, s73
    s_lshl_b32 s78, s78, 12
    s_add_u32 s78, s78, 0x1740000
    s_add_u32 s78, s78, s66
    s_and_b32 s96, s57, 3
    s_lshl_b32 s96, s96, 6
    s_add_u32 s96, s96, s59
    s_lshl_b32 s96, s96, 4
    s_add_u32 s96, s96, s78
    s_lshl_b32 s73, s56, 8
    s_lshl_b32 s74, s57, 3
    s_add_u32 s73, s73, s74
    v_writelane_b32 v12, s73, 0
    v_mul_u32_u24 v8, 576, v6
    v_lshrrev_b32 v9, 4, v0
    v_mul_u32_u24 v9, 144, v9
    v_add3_u32 v13, v8, v9, s95
    s_mov_b32 s76, 0x07060100
    s_mov_b32 s77, 0x05040302
    s_lshl_b32 s98, s57, 4
    s_add_u32 s98, s98, s56
    s_lshl_b32 s98, s98, 8
    s_add_u32 s98, s98, 0x1710000
    v_mov_b32 v180, 0
    v_mov_b32 v181, 0
    v_mov_b32 v182, 0
    v_mov_b32 v183, 0
    v_mov_b32 v184, 0
    v_mov_b32 v185, 0
    v_mov_b32 v186, 0
    v_mov_b32 v187, 0
    v_mov_b32 v188, 0
    s_cmp_eq_u32 s3, 2
    s_cbranch_scc1 L_role_e
    s_cmp_eq_u32 s3, 3
    s_cbranch_scc1 L_role_d
    v_add_u32 v8, 0, v0
    v_mul_u32_u24 v9, 1821, v8
    v_lshrrev_b32 v9, 16, v9
    v_mul_u32_u24 v10, 36, v9
    v_sub_u32 v8, v8, v10
    v_mul_u32_u24 v9, 9216, v9
    v_lshl_add_u32 v9, v8, 4, v9
    v_add_u32 v8, 46, v8
    v_lshrrev_b32 v8, 6, v8
    v_mul_u32_u24 v8, 288, v8
    v_add_u32 v180, v8, v9
    v_add_u32 v8, 64, v0
    v_mul_u32_u24 v9, 1821, v8
    v_lshrrev_b32 v9, 16, v9
    v_mul_u32_u24 v10, 36, v9
    v_sub_u32 v8, v8, v10
    v_mul_u32_u24 v9, 9216, v9
    v_lshl_add_u32 v9, v8, 4, v9
    v_add_u32 v8, 46, v8
    v_lshrrev_b32 v8, 6, v8
    v_mul_u32_u24 v8, 288, v8
    v_add_u32 v181, v8, v9
    v_add_u32 v8, 128, v0
    v_mul_u32_u24 v9, 1821, v8
    v_lshrrev_b32 v9, 16, v9
    v_mul_u32_u24 v10, 36, v9
    v_sub_u32 v8, v8, v10
    v_mul_u32_u24 v9, 9216, v9
    v_lshl_add_u32 v9, v8, 4, v9
    v_add_u32 v8, 46, v8
    v_lshrrev_b32 v8, 6, v8
    v_mul_u32_u24 v8, 288, v8
    v_add_u32 v182, v8, v9
    v_add_u32 v8, 192, v0
    v_mul_u32_u24 v9, 1821, v8
    v_lshrrev_b32 v9, 16, v9
    v_mul_u32_u24 v10, 36, v9
    v_sub_u32 v8, v8, v10
    v_mul_u32_u24 v9, 9216, v9
    v_lshl_add_u32 v9, v8, 4, v9
    v_add_u32 v8, 46, v8
    v_lshrrev_b32 v8, 6, v8
    v_mul_u32_u24 v8, 288, v8
    v_add_u32 v183, v8, v9
    v_add_u32 v8, 256, v0
    v_mul_u32_u24 v9, 1821, v8
    v_lshrrev_b32 v9, 16, v9
    v_mul_u32_u24 v10, 36, v9
    v_sub_u32 v8, v8, v10
    v_mul_u32_u24 v9, 9216, v9
    v_lshl_add_u32 v9, v8, 4, v9
    v_add_u32 v8, 46, v8
    v_lshrrev_b32 v8, 6, v8
    v_mul_u32_u24 v8, 288, v8
    v_add_u32 v184, v8, v9
    v_add_u32 v8, 320, v0
    v_mul_u32_u24 v9, 1821, v8
    v_lshrrev_b32 v9, 16, v9
    v_mul_u32_u24 v10, 36, v9
    v_sub_u32 v8, v8, v10
    v_mul_u32_u24 v9, 9216, v9
    v_lshl_add_u32 v9, v8, 4, v9
    v_add_u32 v8, 46, v8
    v_lshrrev_b32 v8, 6, v8
    v_mul_u32_u24 v8, 288, v8
    v_add_u32 v185, v8, v9
    v_add_u32 v8, 384, v0
    v_mul_u32_u24 v9, 1821, v8
    v_lshrrev_b32 v9, 16, v9
    v_mul_u32_u24 v10, 36, v9
    v_sub_u32 v8, v8, v10
    v_mul_u32_u24 v9, 9216, v9
    v_lshl_add_u32 v9, v8, 4, v9
    v_add_u32 v8, 46, v8
    v_lshrrev_b32 v8, 6, v8
    v_mul_u32_u24 v8, 288, v8
    v_add_u32 v186, v8, v9
    v_add_u32 v8, 448, v0
    v_mul_u32_u24 v9, 1821, v8
    v_lshrrev_b32 v9, 16, v9
    v_mul_u32_u24 v10, 36, v9
    v_sub_u32 v8, v8, v10
    v_mul_u32_u24 v9, 9216, v9
    v_lshl_add_u32 v9, v8, 4, v9
    v_add_u32 v8, 46, v8
    v_lshrrev_b32 v8, 6, v8
    v_mul_u32_u24 v8, 288, v8
    v_add_u32 v187, v8, v9
    v_add_u32 v8, 512, v0
    v_mul_u32_u24 v9, 1821, v8
    v_lshrrev_b32 v9, 16, v9
    v_mul_u32_u24 v10, 36, v9
    v_sub_u32 v8, v8, v10
    v_mul_u32_u24 v9, 9216, v9
    v_lshl_add_u32 v9, v8, 4, v9
    v_add_u32 v8, 46, v8
    v_lshrrev_b32 v8, 6, v8
    v_mul_u32_u24 v8, 288, v8
    v_add_u32 v188, v8, v9
    s_waitcnt vmcnt(4)
    s_add_u32 m0, s95, 0
    s_nop 0
    buffer_load_dwordx4 v180, s[20:23], s68 offen lds
    s_add_u32 m0, s95, 1024
    s_nop 0
    buffer_load_dwordx4 v181, s[20:23], s68 offen lds
    s_add_u32 m0, s95, 2048
    s_nop 0
    buffer_load_dwordx4 v182, s[20:23], s68 offen lds
    s_add_u32 m0, s95, 3072
    s_nop 0
    buffer_load_dwordx4 v183, s[20:23], s68 offen lds
    s_add_u32 m0, s95, 4096
    s_nop 0
    buffer_load_dwordx4 v184, s[20:23], s68 offen lds
    s_add_u32 m0, s95, 5120
    s_nop 0
    buffer_load_dwordx4 v185, s[20:23], s68 offen lds
    s_add_u32 m0, s95, 6144
    s_nop 0
    buffer_load_dwordx4 v186, s[20:23], s68 offen lds
    s_add_u32 m0, s95, 7168
    s_nop 0
    buffer_load_dwordx4 v187, s[20:23], s68 offen lds
    s_add_u32 m0, s95, 8192
    s_nop 0
    buffer_load_dwordx4 v188, s[20:23], s68 offen lds
    s_branch L_role_done
L_role_e:
    s_mov_b32 s20, s42
    s_and_b32 s21, s43, 0xffff
    s_mov_b32 s22, 0xc0000
    s_mov_b32 s23, 0x20000
    v_lshrrev_b32 v9, 2, v0
    v_and_b32 v8, 3, v0
    v_lshlrev_b32 v8, 4, v8
    v_lshl_add_u32 v8, v9, 10, v8
    v_lshlrev_b32 v9, 1, v9
    s_mul_i32 s72, s56, 49152
    s_lshl_b32 s73, s57, 6
    s_add_u32 s72, s72, s73
    s_mul_i32 s73, s56, 96
    buffer_load_dwordx4 v[168:171], v8, s[20:23], s72 offen
    s_add_u32 s72, s72, 16384
    buffer_load_dwordx4 v[172:175], v8, s[20:23], s72 offen
    s_add_u32 s72, s72, 16384
    buffer_load_dwordx4 v[176:179], v8, s[20:23], s72 offen
    buffer_load_ushort v180, v9, s[28:31], s73 offen offset:0
    buffer_load_ushort v181, v9, s[28:31], s73 offen offset:32
    buffer_load_ushort v182, v9, s[28:31], s73 offen offset:64
    buffer_load_ushort v183, v9, s[28:31], s73 offen offset:1536
    buffer_load_ushort v184, v9, s[28:31], s73 offen offset:1568
    buffer_load_ushort v185, v9, s[28:31], s73 offen offset:1600
    s_waitcnt vmcnt(13)
    s_branch L_role_done
L_role_d:
    buffer_load_dword v169, v14, s[24:27], 0 offen sc1
    s_waitcnt vmcnt(5)
    buffer_load_dword v168, v14, s[24:27], 0 offen sc1
L_role_done:
    s_getreg_b32 s97, hwreg(HW_REG_XCC_ID)
    s_and_b32 s97, s97, 15
    s_lshl_b32 s97, s97, 8
    s_add_u32 s97, s97, s2
    s_mov_b32 s61, 0
    v_lshlrev_b32 v64, 16, v16
    v_and_b32 v80, 0xffff0000, v16
    v_lshlrev_b32 v96, 16, v17
    v_and_b32 v112, 0xffff0000, v17
    v_lshlrev_b32 v65, 16, v18
    v_and_b32 v81, 0xffff0000, v18
    v_lshlrev_b32 v97, 16, v19
    v_and_b32 v113, 0xffff0000, v19
    v_lshlrev_b32 v66, 16, v20
    v_and_b32 v82, 0xffff0000, v20
    v_lshlrev_b32 v98, 16, v21
    v_and_b32 v114, 0xffff0000, v21
    v_lshlrev_b32 v67, 16, v22
    v_and_b32 v83, 0xffff0000, v22
    v_lshlrev_b32 v99, 16, v23
    v_and_b32 v115, 0xffff0000, v23
    v_lshlrev_b32 v68, 16, v24
    v_and_b32 v84, 0xffff0000, v24
    v_lshlrev_b32 v100, 16, v25
    v_and_b32 v116, 0xffff0000, v25
    v_lshlrev_b32 v69, 16, v26
    v_and_b32 v85, 0xffff0000, v26
    v_lshlrev_b32 v101, 16, v27
    v_and_b32 v117, 0xffff0000, v27
    v_lshlrev_b32 v70, 16, v28
    v_and_b32 v86, 0xffff0000, v28
    v_lshlrev_b32 v102, 16, v29
    v_and_b32 v118, 0xffff0000, v29
    v_lshlrev_b32 v71, 16, v30
    v_and_b32 v87, 0xffff0000, v30
    v_lshlrev_b32 v103, 16, v31
    v_and_b32 v119, 0xffff0000, v31
    v_lshlrev_b32 v72, 16, v32
    v_and_b32 v88, 0xffff0000, v32
    v_lshlrev_b32 v104, 16, v33
    v_and_b32 v120, 0xffff0000, v33
    v_lshlrev_b32 v73, 16, v34
    v_and_b32 v89, 0xffff0000, v34
    v_lshlrev_b32 v105, 16, v35
    v_and_b32 v121, 0xffff0000, v35
    v_lshlrev_b32 v74, 16, v36
    v_and_b32 v90, 0xffff0000, v36
    v_lshlrev_b32 v106, 16, v37
    v_and_b32 v122, 0xffff0000, v37
    v_lshlrev_b32 v75, 16, v38
    v_and_b32 v91, 0xffff0000, v38
    v_lshlrev_b32 v107, 16, v39
    v_and_b32 v123, 0xffff0000, v39
    v_lshlrev_b32 v76, 16, v40
    v_and_b32 v92, 0xffff0000, v40
    v_lshlrev_b32 v108, 16, v41
    v_and_b32 v124, 0xffff0000, v41
    v_lshlrev_b32 v77, 16, v42
    v_and_b32 v93, 0xffff0000, v42
    v_lshlrev_b32 v109, 16, v43
    v_and_b32 v125, 0xffff0000, v43
    v_lshlrev_b32 v78, 16, v44
    v_and_b32 v94, 0xffff0000, v44
    v_lshlrev_b32 v110, 16, v45
    v_and_b32 v126, 0xffff0000, v45
    v_lshlrev_b32 v79, 16, v46
    v_and_b32 v95, 0xffff0000, v46
    v_lshlrev_b32 v111, 16, v47
    v_and_b32 v127, 0xffff0000, v47
L_layer:
    v_pk_add_f32 v[192:193], v[64:65], v[66:67]
    v_pk_add_f32 v[194:195], v[68:69], v[70:71]
    v_pk_add_f32 v[196:197], v[72:73], v[74:75]
    v_pk_add_f32 v[198:199], v[76:77], v[78:79]
    v_pk_add_f32 v[200:201], v[80:81], v[82:83]
    v_pk_add_f32 v[202:203], v[84:85], v[86:87]
    v_pk_add_f32 v[204:205], v[88:89], v[90:91]
    v_pk_add_f32 v[206:207], v[92:93], v[94:95]
    v_pk_add_f32 v[208:209], v[96:97], v[98:99]
    v_pk_add_f32 v[210:211], v[100:101], v[102:103]
    v_pk_add_f32 v[212:213], v[104:105], v[106:107]
    v_pk_add_f32 v[214:215], v[108:109], v[110:111]
    v_pk_add_f32 v[216:217], v[112:113], v[114:115]
    v_pk_add_f32 v[218:219], v[116:117], v[118:119]
    v_pk_add_f32 v[220:221], v[120:121], v[122:123]
    v_pk_add_f32 v[222:223], v[124:125], v[126:127]
    v_pk_add_f32 v[192:193], v[192:193], v[208:209]
    v_pk_add_f32 v[194:195], v[194:195], v[210:211]
    v_pk_add_f32 v[196:197], v[196:197], v[212:213]
    v_pk_add_f32 v[198:199], v[198:199], v[214:215]
    v_pk_add_f32 v[200:201], v[200:201], v[216:217]
    v_pk_add_f32 v[202:203], v[202:203], v[218:219]
    v_pk_add_f32 v[204:205], v[204:205], v[220:221]
    v_pk_add_f32 v[206:207], v[206:207], v[222:223]
    v_pk_add_f32 v[192:193], v[192:193], v[200:201]
    v_pk_add_f32 v[194:195], v[194:195], v[202:203]
    v_pk_add_f32 v[196:197], v[196:197], v[204:205]
    v_pk_add_f32 v[198:199], v[198:199], v[206:207]
    v_pk_add_f32 v[192:193], v[192:193], v[196:197]
    v_pk_add_f32 v[194:195], v[194:195], v[198:199]
    v_pk_add_f32 v[192:193], v[192:193], v[194:195]
    v_add_f32 v8, v192, v193
    s_nop 1
    v_add_f32_dpp v8, v8, v8 quad_perm:[1,0,3,2] row_mask:0xf bank_mask:0xf
    s_nop 1
    v_add_f32_dpp v8, v8, v8 quad_perm:[2,3,0,1] row_mask:0xf bank_mask:0xf
    s_nop 1
    v_add_f32_dpp v8, v8, v8 row_half_mirror row_mask:0xf bank_mask:0xf
    s_nop 1
    v_add_f32_dpp v8, v8, v8 row_mirror row_mask:0xf bank_mask:0xf
    v_mov_b32 v10, v8
    s_nop 1
    v_permlane16_swap_b32 v8, v10
    s_nop 1
    v_add_f32 v8, v8, v10
    v_mov_b32 v10, v8
    s_nop 1
    v_permlane32_swap_b32 v8, v10
    s_nop 1
    v_add_f32 v8, v8, v10
    v_mul_f32 v8, 0xb9800000, v8
    v_pk_add_f32 v[192:193], v[64:65], v[8:9] op_sel_hi:[1,0]
    v_pk_mul_f32 v[224:225], v[192:193], v[192:193]
    v_pk_add_f32 v[194:195], v[66:67], v[8:9] op_sel_hi:[1,0]
    v_pk_mul_f32 v[226:227], v[194:195], v[194:195]
    v_pk_add_f32 v[196:197], v[68:69], v[8:9] op_sel_hi:[1,0]
    v_pk_mul_f32 v[228:229], v[196:197], v[196:197]
    v_pk_add_f32 v[198:199], v[70:71], v[8:9] op_sel_hi:[1,0]
    v_pk_mul_f32 v[230:231], v[198:199], v[198:199]
    v_pk_add_f32 v[200:201], v[72:73], v[8:9] op_sel_hi:[1,0]
    v_pk_fma_f32 v[224:225], v[200:201], v[200:201], v[224:225]
    v_pk_add_f32 v[202:203], v[74:75], v[8:9] op_sel_hi:[1,0]
    v_pk_fma_f32 v[226:227], v[202:203], v[202:203], v[226:227]
    v_pk_add_f32 v[204:205], v[76:77], v[8:9] op_sel_hi:[1,0]
    v_pk_fma_f32 v[228:229], v[204:205], v[204:205], v[228:229]
    v_pk_add_f32 v[206:207], v[78:79], v[8:9] op_sel_hi:[1,0]
    v_pk_fma_f32 v[230:231], v[206:207], v[206:207], v[230:231]
    v_pk_add_f32 v[192:193], v[80:81], v[8:9] op_sel_hi:[1,0]
    v_pk_fma_f32 v[224:225], v[192:193], v[192:193], v[224:225]
    v_pk_add_f32 v[194:195], v[82:83], v[8:9] op_sel_hi:[1,0]
    v_pk_fma_f32 v[226:227], v[194:195], v[194:195], v[226:227]
    v_pk_add_f32 v[196:197], v[84:85], v[8:9] op_sel_hi:[1,0]
    v_pk_fma_f32 v[228:229], v[196:197], v[196:197], v[228:229]
    v_pk_add_f32 v[198:199], v[86:87], v[8:9] op_sel_hi:[1,0]
    v_pk_fma_f32 v[230:231], v[198:199], v[198:199], v[230:231]
    v_pk_add_f32 v[200:201], v[88:89], v[8:9] op_sel_hi:[1,0]
    v_pk_fma_f32 v[224:225], v[200:201], v[200:201], v[224:225]
    v_pk_add_f32 v[202:203], v[90:91], v[8:9] op_sel_hi:[1,0]
    v_pk_fma_f32 v[226:227], v[202:203], v[202:203], v[226:227]
    v_pk_add_f32 v[204:205], v[92:93], v[8:9] op_sel_hi:[1,0]
    v_pk_fma_f32 v[228:229], v[204:205], v[204:205], v[228:229]
    v_pk_add_f32 v[206:207], v[94:95], v[8:9] op_sel_hi:[1,0]
    v_pk_fma_f32 v[230:231], v[206:207], v[206:207], v[230:231]
    v_pk_add_f32 v[192:193], v[96:97], v[8:9] op_sel_hi:[1,0]
    v_pk_fma_f32 v[224:225], v[192:193], v[192:193], v[224:225]
    v_pk_add_f32 v[194:195], v[98:99], v[8:9] op_sel_hi:[1,0]
    v_pk_fma_f32 v[226:227], v[194:195], v[194:195], v[226:227]
    v_pk_add_f32 v[196:197], v[100:101], v[8:9] op_sel_hi:[1,0]
    v_pk_fma_f32 v[228:229], v[196:197], v[196:197], v[228:229]
    v_pk_add_f32 v[198:199], v[102:103], v[8:9] op_sel_hi:[1,0]
    v_pk_fma_f32 v[230:231], v[198:199], v[198:199], v[230:231]
    v_pk_add_f32 v[200:201], v[104:105], v[8:9] op_sel_hi:[1,0]
    v_pk_fma_f32 v[224:225], v[200:201], v[200:201], v[224:225]
    v_pk_add_f32 v[202:203], v[106:107], v[8:9] op_sel_hi:[1,0]
    v_pk_fma_f32 v[226:227], v[202:203], v[202:203], v[226:227]
    v_pk_add_f32 v[204:205], v[108:109], v[8:9] op_sel_hi:[1,0]
    v_pk_fma_f32 v[228:229], v[204:205], v[204:205], v[228:229]
    v_pk_add_f32 v[206:207], v[110:111], v[8:9] op_sel_hi:[1,0]
    v_pk_fma_f32 v[230:231], v[206:207], v[206:207], v[230:231]
    v_pk_add_f32 v[192:193], v[112:113], v[8:9] op_sel_hi:[1,0]
    v_pk_fma_f32 v[224:225], v[192:193], v[192:193], v[224:225]
    v_pk_add_f32 v[194:195], v[114:115], v[8:9] op_sel_hi:[1,0]
    v_pk_fma_f32 v[226:227], v[194:195], v[194:195], v[226:227]
    v_pk_add_f32 v[196:197], v[116:117], v[8:9] op_sel_hi:[1,0]
    v_pk_fma_f32 v[228:229], v[196:197], v[196:197], v[228:229]
    v_pk_add_f32 v[198:199], v[118:119], v[8:9] op_sel_hi:[1,0]
    v_pk_fma_f32 v[230:231], v[198:199], v[198:199], v[230:231]
    v_pk_add_f32 v[200:201], v[120:121], v[8:9] op_sel_hi:[1,0]
    v_pk_fma_f32 v[224:225], v[200:201], v[200:201], v[224:225]
    v_pk_add_f32 v[202:203], v[122:123], v[8:9] op_sel_hi:[1,0]
    v_pk_fma_f32 v[226:227], v[202:203], v[202:203], v[226:227]
    v_pk_add_f32 v[204:205], v[124:125], v[8:9] op_sel_hi:[1,0]
    v_pk_fma_f32 v[228:229], v[204:205], v[204:205], v[228:229]
    v_pk_add_f32 v[206:207], v[126:127], v[8:9] op_sel_hi:[1,0]
    v_pk_fma_f32 v[230:231], v[206:207], v[206:207], v[230:231]
    v_pk_add_f32 v[224:225], v[224:225], v[226:227]
    v_pk_add_f32 v[228:229], v[228:229], v[230:231]
    v_pk_add_f32 v[224:225], v[224:225], v[228:229]
    v_add_f32 v9, v224, v225
    s_nop 1
    v_add_f32_dpp v9, v9, v9 quad_perm:[1,0,3,2] row_mask:0xf bank_mask:0xf
    s_nop 1
    v_add_f32_dpp v9, v9, v9 quad_perm:[2,3,0,1] row_mask:0xf bank_mask:0xf
    s_nop 1
    v_add_f32_dpp v9, v9, v9 row_half_mirror row_mask:0xf bank_mask:0xf
    s_nop 1
    v_add_f32_dpp v9, v9, v9 row_mirror row_mask:0xf bank_mask:0xf
    v_mov_b32 v10, v9
    s_nop 1
    v_permlane16_swap_b32 v9, v10
    s_nop 1
    v_add_f32 v9, v9, v10
    v_mov_b32 v10, v9
    s_nop 1
    v_permlane32_swap_b32 v9, v10
    s_nop 1
    v_add_f32 v9, v9, v10
    s_lshl_b32 s72, s3, 3
    s_add_u32 s72, s72, 131072
    v_mov_b32 v10, s72
    s_mov_b64 exec, 1
    ds_write_b64 v10, v[8:9]
    s_mov_b64 exec, -1
    v_mov_b32 v10, 131072
    s_mov_b32 s32, 0x3f400000
    s_mov_b32 s33, 0x3fc00000
    s_mov_b32 s34, 0x3f100000
    s_mov_b32 s35, 0x40100000
    s_mov_b32 s36, 0x3fa20000
    s_mov_b32 s37, 0x40340000
    s_waitcnt lgkmcnt(0)
    s_barrier
    s_cmp_lg_u32 s3, 3
    s_cbranch_scc1 L_side_a
    ds_read_b128 v[128:131], v10
    ds_read_b128 v[132:135], v10 offset:16
    s_cmp_eq_u32 s61, 0
    s_cbranch_scc1 L_resolve
L_resolve_back:
    v_mov_b32 v137, s61
    v_mov_b32 v139, s61
    v_and_b32 v8, 31, v0
    v_lshlrev_b32 v8, 7, v8
    s_waitcnt lgkmcnt(0)
    v_add_f32 v136, v128, v130
    v_add_f32 v141, v132, v134
    v_add_f32 v136, v136, v141
    v_mul_f32 v136, 0x3e800000, v136
    v_add_f32 v138, v129, v131
    v_add_f32 v141, v133, v135
    v_add_f32 v138, v138, v141
    v_sub_f32 v128, v128, v136
    v_sub_f32 v130, v130, v136
    v_sub_f32 v132, v132, v136
    v_sub_f32 v134, v134, v136
    v_mul_f32 v140, v128, v128
    v_fmac_f32 v140, v130, v130
    v_fmac_f32 v140, v132, v132
    v_fmac_f32 v140, v134, v134
    v_fmac_f32 v138, 0x45800000, v140
    s_mov_b64 exec, 1
    buffer_store_dwordx4 v[136:139], v14, s[4:7], s96 offen sc0 sc1
    s_mov_b64 exec, -1
    s_mov_b32 s71, 100000
L_spoll:
    buffer_load_dwordx4 v[176:179], v8, s[4:7], s78 offen sc1
    s_waitcnt vmcnt(0)
    v_cmp_ne_u32 vcc, s61, v177
    v_cmp_ne_u32 s[80:81], s61, v179
    s_nop 1
    s_or_b64 s[80:81], s[80:81], vcc
    s_cbranch_scc0 L_sready
    s_sleep 1
    s_sub_u32 s71, s71, 1
    s_cmp_lg_u32 s71, 0
    s_cbranch_scc1 L_spoll
L_sready:
    v_mov_b32 v128, v176
    s_nop 1
    v_add_f32_dpp v128, v128, v128 quad_perm:[1,0,3,2] row_mask:0xf bank_mask:0xf
    s_nop 1
    v_add_f32_dpp v128, v128, v128 quad_perm:[2,3,0,1] row_mask:0xf bank_mask:0xf
    s_nop 1
    v_add_f32_dpp v128, v128, v128 row_half_mirror row_mask:0xf bank_mask:0xf
    s_nop 1
    v_add_f32_dpp v128, v128, v128 row_mirror row_mask:0xf bank_mask:0xf
    v_mov_b32 v130, v128
    s_nop 1
    v_permlane16_swap_b32 v128, v130
    s_nop 1
    v_add_f32 v128, v128, v130
    v_mul_f32 v128, 0x3d000000, v128
    v_sub_f32 v176, v176, v128
    v_mul_f32 v176, v176, v176
    v_fmac_f32 v178, 0x46800000, v176
    s_nop 1
    v_add_f32_dpp v178, v178, v178 quad_perm:[1,0,3,2] row_mask:0xf bank_mask:0xf
    s_nop 1
    v_add_f32_dpp v178, v178, v178 quad_perm:[2,3,0,1] row_mask:0xf bank_mask:0xf
    s_nop 1
    v_add_f32_dpp v178, v178, v178 row_half_mirror row_mask:0xf bank_mask:0xf
    s_nop 1
    v_add_f32_dpp v178, v178, v178 row_mirror row_mask:0xf bank_mask:0xf
    v_mov_b32 v130, v178
    s_nop 1
    v_permlane16_swap_b32 v178, v130
    s_nop 1
    v_add_f32 v178, v178, v130
    v_mov_b32 v130, 0x3727c5ac
    v_fmac_f32 v130, 0x36000000, v178
    v_rsq_f32 v129, v130
    s_nop 0
    v_mul_f32 v131, v130, v129
    v_mul_f32 v131, v131, v129
    v_mov_b32 v130, 0x3fc00000
    v_fmac_f32 v130, -0.5, v131
    v_mul_f32 v129, v129, v130
    v_mov_b32 v130, s61
    v_mov_b32 v131, s61
    s_mov_b64 exec, 1
    ds_write_b128 v10, v[128:131] offset:32
    ds_write_b32 v10, v14 offset:64
    s_mov_b64 exec, -1
    s_branch L_side_done
L_side_a:
    s_waitcnt vmcnt(0)
    s_cmp_eq_u32 s87, 0
    s_cbranch_scc1 L_side_b
    ds_read_b128 v[16:19], v13 offset:0
    ds_read_b128 v[20:23], v13 offset:16
    ds_read_b128 v[24:27], v13 offset:32
    ds_read_b128 v[28:31], v13 offset:48
    ds_read_b128 v[32:35], v13 offset:64
    ds_read_b128 v[36:39], v13 offset:80
    ds_read_b128 v[40:43], v13 offset:96
    ds_read_b128 v[44:47], v13 offset:112
    ds_read_b128 v[224:227], v13 offset:128
    s_waitcnt lgkmcnt(0)
    v_lshlrev_b32 v128, 16, v16
    v_and_b32 v129, 0xffff0000, v20
    v_and_b32 v130, 0xffff0000, v16
    v_lshlrev_b32 v131, 16, v21
    v_lshlrev_b32 v132, 16, v17
    v_and_b32 v133, 0xffff0000, v21
    v_perm_b32 v168, v20, v16, s76
    v_perm_b32 v172, v21, v17, s76
    v_pk_fma_f32 v[134:135], v[132:133], s[34:35], v[128:129] op_sel:[0,0,0] op_sel_hi:[1,0,1]
    v_pk_fma_f32 v[128:129], v[132:133], s[34:35], v[128:129] op_sel:[0,1,0] op_sel_hi:[1,1,1]
    v_pk_fma_f32 v[136:137], v[130:131], s[32:33], v[134:135] op_sel:[0,0,0] op_sel_hi:[1,0,1]
    v_pk_fma_f32 v[134:135], v[130:131], s[32:33], v[134:135] op_sel:[0,0,0] op_sel_hi:[1,0,1] neg_lo:[0,1,0] neg_hi:[0,1,0]
    v_pk_fma_f32 v[138:139], v[130:131], s[32:33], v[128:129] op_sel:[0,1,0] op_sel_hi:[1,1,1]
    v_pk_fma_f32 v[128:129], v[130:131], s[32:33], v[128:129] op_sel:[0,1,0] op_sel_hi:[1,1,1] neg_lo:[0,1,0] neg_hi:[0,1,0]
    v_cvt_pk_bf16_f32 v152, v136, v137
    v_cvt_pk_bf16_f32 v156, v134, v135
    v_cvt_pk_bf16_f32 v160, v138, v139
    v_cvt_pk_bf16_f32 v164, v128, v129
    v_lshlrev_b32 v128, 16, v25
    v_and_b32 v129, 0xffff0000, v29
    v_and_b32 v130, 0xffff0000, v25
    v_lshlrev_b32 v131, 16, v30
    v_lshlrev_b32 v132, 16, v26
    v_and_b32 v133, 0xffff0000, v30
    v_perm_b32 v169, v29, v25, s76
    v_perm_b32 v173, v30, v26, s76
    v_pk_fma_f32 v[134:135], v[132:133], s[34:35], v[128:129] op_sel:[0,0,0] op_sel_hi:[1,0,1]
    v_pk_fma_f32 v[128:129], v[132:133], s[34:35], v[128:129] op_sel:[0,1,0] op_sel_hi:[1,1,1]
    v_pk_fma_f32 v[136:137], v[130:131], s[32:33], v[134:135] op_sel:[0,0,0] op_sel_hi:[1,0,1]
    v_pk_fma_f32 v[134:135], v[130:131], s[32:33], v[134:135] op_sel:[0,0,0] op_sel_hi:[1,0,1] neg_lo:[0,1,0] neg_hi:[0,1,0]
    v_pk_fma_f32 v[138:139], v[130:131], s[32:33], v[128:129] op_sel:[0,1,0] op_sel_hi:[1,1,1]
    v_pk_fma_f32 v[128:129], v[130:131], s[32:33], v[128:129] op_sel:[0,1,0] op_sel_hi:[1,1,1] neg_lo:[0,1,0] neg_hi:[0,1,0]
    v_cvt_pk_bf16_f32 v153, v136, v137
    v_cvt_pk_bf16_f32 v157, v134, v135
    v_cvt_pk_bf16_f32 v161, v138, v139
    v_cvt_pk_bf16_f32 v165, v128, v129
    v_and_b32 v128, 0xffff0000, v17
    v_lshlrev_b32 v129, 16, v22
    v_lshlrev_b32 v130, 16, v18
    v_and_b32 v131, 0xffff0000, v22
    v_and_b32 v132, 0xffff0000, v18
    v_lshlrev_b32 v133, 16, v23
    v_perm_b32 v192, v22, v17, s77
    v_perm_b32 v196, v23, v18, s77
    v_pk_fma_f32 v[134:135], v[132:133], s[34:35], v[128:129] op_sel:[0,0,0] op_sel_hi:[1,0,1]
    v_pk_fma_f32 v[128:129], v[132:133], s[34:35], v[128:129] op_sel:[0,1,0] op_sel_hi:[1,1,1]
    v_pk_fma_f32 v[136:137], v[130:131], s[32:33], v[134:135] op_sel:[0,0,0] op_sel_hi:[1,0,1]
    v_pk_fma_f32 v[134:135], v[130:131], s[32:33], v[134:135] op_sel:[0,0,0] op_sel_hi:[1,0,1] neg_lo:[0,1,0] neg_hi:[0,1,0]
    v_pk_fma_f32 v[138:139], v[130:131], s[32:33], v[128:129] op_sel:[0,1,0] op_sel_hi:[1,1,1]
    v_pk_fma_f32 v[128:129], v[130:131], s[32:33], v[128:129] op_sel:[0,1,0] op_sel_hi:[1,1,1] neg_lo:[0,1,0] neg_hi:[0,1,0]
    v_cvt_pk_bf16_f32 v176, v136, v137
    v_cvt_pk_bf16_f32 v180, v134, v135
    v_cvt_pk_bf16_f32 v184, v138, v139
    v_cvt_pk_bf16_f32 v188, v128, v129
    v_and_b32 v128, 0xffff0000, v26
    v_lshlrev_b32 v129, 16, v31
    v_lshlrev_b32 v130, 16, v27
    v_and_b32 v131, 0xffff0000, v31
    v_and_b32 v132, 0xffff0000, v27
    v_lshlrev_b32 v133, 16, v32
    v_perm_b32 v193, v31, v26, s77
    v_perm_b32 v197, v32, v27, s77
    v_pk_fma_f32 v[134:135], v[132:133], s[34:35], v[128:129] op_sel:[0,0,0] op_sel_hi:[1,0,1]
    v_pk_fma_f32 v[128:129], v[132:133], s[34:35], v[128:129] op_sel:[0,1,0] op_sel_hi:[1,1,1]
    v_pk_fma_f32 v[136:137], v[130:131], s[32:33], v[134:135] op_sel:[0,0,0] op_sel_hi:[1,0,1]
    v_pk_fma_f32 v[134:135], v[130:131], s[32:33], v[134:135] op_sel:[0,0,0] op_sel_hi:[1,0,1] neg_lo:[0,1,0] neg_hi:[0,1,0]
    v_pk_fma_f32 v[138:139], v[130:131], s[32:33], v[128:129] op_sel:[0,1,0] op_sel_hi:[1,1,1]
    v_pk_fma_f32 v[128:129], v[130:131], s[32:33], v[128:129] op_sel:[0,1,0] op_sel_hi:[1,1,1] neg_lo:[0,1,0] neg_hi:[0,1,0]
    v_cvt_pk_bf16_f32 v177, v136, v137
    v_cvt_pk_bf16_f32 v181, v134, v135
    v_cvt_pk_bf16_f32 v185, v138, v139
    v_cvt_pk_bf16_f32 v189, v128, v129
    v_lshlrev_b32 v128, 16, v19
    v_and_b32 v129, 0xffff0000, v23
    v_and_b32 v130, 0xffff0000, v19
    v_lshlrev_b32 v131, 16, v24
    v_lshlrev_b32 v132, 16, v20
    v_and_b32 v133, 0xffff0000, v24
    v_perm_b32 v216, v23, v19, s76
    v_perm_b32 v220, v24, v20, s76
    v_pk_fma_f32 v[134:135], v[132:133], s[34:35], v[128:129] op_sel:[0,0,0] op_sel_hi:[1,0,1]
    v_pk_fma_f32 v[128:129], v[132:133], s[34:35], v[128:129] op_sel:[0,1,0] op_sel_hi:[1,1,1]
    v_pk_fma_f32 v[136:137], v[130:131], s[32:33], v[134:135] op_sel:[0,0,0] op_sel_hi:[1,0,1]
    v_pk_fma_f32 v[134:135], v[130:131], s[32:33], v[134:135] op_sel:[0,0,0] op_sel_hi:[1,0,1] neg_lo:[0,1,0] neg_hi:[0,1,0]
    v_pk_fma_f32 v[138:139], v[130:131], s[32:33], v[128:129] op_sel:[0,1,0] op_sel_hi:[1,1,1]
    v_pk_fma_f32 v[128:129], v[130:131], s[32:33], v[128:129] op_sel:[0,1,0] op_sel_hi:[1,1,1] neg_lo:[0,1,0] neg_hi:[0,1,0]
    v_cvt_pk_bf16_f32 v200, v136, v137
    v_cvt_pk_bf16_f32 v204, v134, v135
    v_cvt_pk_bf16_f32 v208, v138, v139
    v_cvt_pk_bf16_f32 v212, v128, v129
    v_lshlrev_b32 v128, 16, v28
    v_and_b32 v129, 0xffff0000, v32
    v_and_b32 v130, 0xffff0000, v28
    v_lshlrev_b32 v131, 16, v33
    v_lshlrev_b32 v132, 16, v29
    v_and_b32 v133, 0xffff0000, v33
    v_perm_b32 v217, v32, v28, s76
    v_perm_b32 v221, v33, v29, s76
    v_pk_fma_f32 v[134:135], v[132:133], s[34:35], v[128:129] op_sel:[0,0,0] op_sel_hi:[1,0,1]
    v_pk_fma_f32 v[128:129], v[132:133], s[34:35], v[128:129] op_sel:[0,1,0] op_sel_hi:[1,1,1]
    v_pk_fma_f32 v[136:137], v[130:131], s[32:33], v[134:135] op_sel:[0,0,0] op_sel_hi:[1,0,1]
    v_pk_fma_f32 v[134:135], v[130:131], s[32:33], v[134:135] op_sel:[0,0,0] op_sel_hi:[1,0,1] neg_lo:[0,1,0] neg_hi:[0,1,0]
    v_pk_fma_f32 v[138:139], v[130:131], s[32:33], v[128:129] op_sel:[0,1,0] op_sel_hi:[1,1,1]
    v_pk_fma_f32 v[128:129], v[130:131], s[32:33], v[128:129] op_sel:[0,1,0] op_sel_hi:[1,1,1] neg_lo:[0,1,0] neg_hi:[0,1,0]
    v_cvt_pk_bf16_f32 v201, v136, v137
    v_cvt_pk_bf16_f32 v205, v134, v135
    v_cvt_pk_bf16_f32 v209, v138, v139
    v_cvt_pk_bf16_f32 v213, v128, v129
    v_lshlrev_b32 v140, 16, v34
    v_and_b32 v141, 0xffff0000, v38
    v_and_b32 v142, 0xffff0000, v34
    v_lshlrev_b32 v143, 16, v39
    v_lshlrev_b32 v144, 16, v35
    v_and_b32 v145, 0xffff0000, v39
    v_perm_b32 v170, v38, v34, s76
    v_perm_b32 v174, v39, v35, s76
    v_pk_fma_f32 v[146:147], v[144:145], s[34:35], v[140:141] op_sel:[0,0,0] op_sel_hi:[1,0,1]
    v_pk_fma_f32 v[140:141], v[144:145], s[34:35], v[140:141] op_sel:[0,1,0] op_sel_hi:[1,1,1]
    v_pk_fma_f32 v[148:149], v[142:143], s[32:33], v[146:147] op_sel:[0,0,0] op_sel_hi:[1,0,1]
    v_pk_fma_f32 v[146:147], v[142:143], s[32:33], v[146:147] op_sel:[0,0,0] op_sel_hi:[1,0,1] neg_lo:[0,1,0] neg_hi:[0,1,0]
    v_pk_fma_f32 v[150:151], v[142:143], s[32:33], v[140:141] op_sel:[0,1,0] op_sel_hi:[1,1,1]
    v_pk_fma_f32 v[140:141], v[142:143], s[32:33], v[140:141] op_sel:[0,1,0] op_sel_hi:[1,1,1] neg_lo:[0,1,0] neg_hi:[0,1,0]
    v_cvt_pk_bf16_f32 v154, v148, v149
    v_cvt_pk_bf16_f32 v158, v146, v147
    v_cvt_pk_bf16_f32 v162, v150, v151
    v_cvt_pk_bf16_f32 v166, v140, v141
    v_lshlrev_b32 v140, 16, v43
    v_and_b32 v141, 0xffff0000, v47
    v_and_b32 v142, 0xffff0000, v43
    v_lshlrev_b32 v143, 16, v224
    v_lshlrev_b32 v144, 16, v44
    v_and_b32 v145, 0xffff0000, v224
    v_perm_b32 v171, v47, v43, s76
    v_perm_b32 v175, v224, v44, s76
    v_pk_fma_f32 v[146:147], v[144:145], s[34:35], v[140:141] op_sel:[0,0,0] op_sel_hi:[1,0,1]
    v_pk_fma_f32 v[140:141], v[144:145], s[34:35], v[140:141] op_sel:[0,1,0] op_sel_hi:[1,1,1]
    v_pk_fma_f32 v[148:149], v[142:143], s[32:33], v[146:147] op_sel:[0,0,0] op_sel_hi:[1,0,1]
    v_pk_fma_f32 v[146:147], v[142:143], s[32:33], v[146:147] op_sel:[0,0,0] op_sel_hi:[1,0,1] neg_lo:[0,1,0] neg_hi:[0,1,0]
    v_pk_fma_f32 v[150:151], v[142:143], s[32:33], v[140:141] op_sel:[0,1,0] op_sel_hi:[1,1,1]
    v_pk_fma_f32 v[140:141], v[142:143], s[32:33], v[140:141] op_sel:[0,1,0] op_sel_hi:[1,1,1] neg_lo:[0,1,0] neg_hi:[0,1,0]
    v_cvt_pk_bf16_f32 v155, v148, v149
    v_cvt_pk_bf16_f32 v159, v146, v147
    v_cvt_pk_bf16_f32 v163, v150, v151
    v_cvt_pk_bf16_f32 v167, v140, v141
    v_and_b32 v140, 0xffff0000, v35
    v_lshlrev_b32 v141, 16, v40
    v_lshlrev_b32 v142, 16, v36
    v_and_b32 v143, 0xffff0000, v40
    v_and_b32 v144, 0xffff0000, v36
    v_lshlrev_b32 v145, 16, v41
    v_perm_b32 v194, v40, v35, s77
    v_perm_b32 v198, v41, v36, s77
    v_pk_fma_f32 v[146:147], v[144:145], s[34:35], v[140:141] op_sel:[0,0,0] op_sel_hi:[1,0,1]
    v_pk_fma_f32 v[140:141], v[144:145], s[34:35], v[140:141] op_sel:[0,1,0] op_sel_hi:[1,1,1]
    v_pk_fma_f32 v[148:149], v[142:143], s[32:33], v[146:147] op_sel:[0,0,0] op_sel_hi:[1,0,1]
    v_pk_fma_f32 v[146:147], v[142:143], s[32:33], v[146:147] op_sel:[0,0,0] op_sel_hi:[1,0,1] neg_lo:[0,1,0] neg_hi:[0,1,0]
    v_pk_fma_f32 v[150:151], v[142:143], s[32:33], v[140:141] op_sel:[0,1,0] op_sel_hi:[1,1,1]
    v_pk_fma_f32 v[140:141], v[142:143], s[32:33], v[140:141] op_sel:[0,1,0] op_sel_hi:[1,1,1] neg_lo:[0,1,0] neg_hi:[0,1,0]
    v_cvt_pk_bf16_f32 v178, v148, v149
    v_cvt_pk_bf16_f32 v182, v146, v147
    v_cvt_pk_bf16_f32 v186, v150, v151
    v_cvt_pk_bf16_f32 v190, v140, v141
    v_and_b32 v140, 0xffff0000, v44
    v_lshlrev_b32 v141, 16, v225
    v_lshlrev_b32 v142, 16, v45
    v_and_b32 v143, 0xffff0000, v225
    v_and_b32 v144, 0xffff0000, v45
    v_lshlrev_b32 v145, 16, v226
    v_perm_b32 v195, v225, v44, s77
    v_perm_b32 v199, v226, v45, s77
    v_pk_fma_f32 v[146:147], v[144:145], s[34:35], v[140:141] op_sel:[0,0,0] op_sel_hi:[1,0,1]
    v_pk_fma_f32 v[140:141], v[144:145], s[34:35], v[140:141] op_sel:[0,1,0] op_sel_hi:[1,1,1]
    v_pk_fma_f32 v[148:149], v[142:143], s[32:33], v[146:147] op_sel:[0,0,0] op_sel_hi:[1,0,1]
    v_pk_fma_f32 v[146:147], v[142:143], s[32:33], v[146:147] op_sel:[0,0,0] op_sel_hi:[1,0,1] neg_lo:[0,1,0] neg_hi:[0,1,0]
    v_pk_fma_f32 v[150:151], v[142:143], s[32:33], v[140:141] op_sel:[0,1,0] op_sel_hi:[1,1,1]
    v_pk_fma_f32 v[140:141], v[142:143], s[32:33], v[140:141] op_sel:[0,1,0] op_sel_hi:[1,1,1] neg_lo:[0,1,0] neg_hi:[0,1,0]
    v_cvt_pk_bf16_f32 v179, v148, v149
    v_cvt_pk_bf16_f32 v183, v146, v147
    v_cvt_pk_bf16_f32 v187, v150, v151
    v_cvt_pk_bf16_f32 v191, v140, v141
    v_lshlrev_b32 v140, 16, v37
    v_and_b32 v141, 0xffff0000, v41
    v_and_b32 v142, 0xffff0000, v37
    v_lshlrev_b32 v143, 16, v42
    v_lshlrev_b32 v144, 16, v38
    v_and_b32 v145, 0xffff0000, v42
    v_perm_b32 v218, v41, v37, s76
    v_perm_b32 v222, v42, v38, s76
    v_pk_fma_f32 v[146:147], v[144:145], s[34:35], v[140:141] op_sel:[0,0,0] op_sel_hi:[1,0,1]
    v_pk_fma_f32 v[140:141], v[144:145], s[34:35], v[140:141] op_sel:[0,1,0] op_sel_hi:[1,1,1]
    v_pk_fma_f32 v[148:149], v[142:143], s[32:33], v[146:147] op_sel:[0,0,0] op_sel_hi:[1,0,1]
    v_pk_fma_f32 v[146:147], v[142:143], s[32:33], v[146:147] op_sel:[0,0,0] op_sel_hi:[1,0,1] neg_lo:[0,1,0] neg_hi:[0,1,0]
    v_pk_fma_f32 v[150:151], v[142:143], s[32:33], v[140:141] op_sel:[0,1,0] op_sel_hi:[1,1,1]
    v_pk_fma_f32 v[140:141], v[142:143], s[32:33], v[140:141] op_sel:[0,1,0] op_sel_hi:[1,1,1] neg_lo:[0,1,0] neg_hi:[0,1,0]
    v_cvt_pk_bf16_f32 v202, v148, v149
    v_cvt_pk_bf16_f32 v206, v146, v147
    v_cvt_pk_bf16_f32 v210, v150, v151
    v_cvt_pk_bf16_f32 v214, v140, v141
    v_lshlrev_b32 v140, 16, v46
    v_and_b32 v141, 0xffff0000, v226
    v_and_b32 v142, 0xffff0000, v46
    v_lshlrev_b32 v143, 16, v227
    v_lshlrev_b32 v144, 16, v47
    v_and_b32 v145, 0xffff0000, v227
    v_perm_b32 v219, v226, v46, s76
    v_perm_b32 v223, v227, v47, s76
    v_pk_fma_f32 v[146:147], v[144:145], s[34:35], v[140:141] op_sel:[0,0,0] op_sel_hi:[1,0,1]
    v_pk_fma_f32 v[140:141], v[144:145], s[34:35], v[140:141] op_sel:[0,1,0] op_sel_hi:[1,1,1]
    v_pk_fma_f32 v[148:149], v[142:143], s[32:33], v[146:147] op_sel:[0,0,0] op_sel_hi:[1,0,1]
    v_pk_fma_f32 v[146:147], v[142:143], s[32:33], v[146:147] op_sel:[0,0,0] op_sel_hi:[1,0,1] neg_lo:[0,1,0] neg_hi:[0,1,0]
    v_pk_fma_f32 v[150:151], v[142:143], s[32:33], v[140:141] op_sel:[0,1,0] op_sel_hi:[1,1,1]
    v_pk_fma_f32 v[140:141], v[142:143], s[32:33], v[140:141] op_sel:[0,1,0] op_sel_hi:[1,1,1] neg_lo:[0,1,0] neg_hi:[0,1,0]
    v_cvt_pk_bf16_f32 v203, v148, v149
    v_cvt_pk_bf16_f32 v207, v146, v147
    v_cvt_pk_bf16_f32 v211, v150, v151
    v_cvt_pk_bf16_f32 v215, v140, v141
    s_branch L_side_done
L_side_b:
    s_cmp_lg_u32 s60, 0
    s_cbranch_scc1 L_side_done
    v_lshlrev_b32 v180, 16, v180
    v_lshlrev_b32 v181, 16, v181
    v_lshlrev_b32 v182, 16, v182
    v_lshlrev_b32 v183, 16, v183
    v_lshlrev_b32 v184, 16, v184
    v_lshlrev_b32 v185, 16, v185
    v_mul_f32 v148, 0xbfb8aa3b, v180
    v_mul_f32 v149, 0xbfb8aa3b, v181
    v_mul_f32 v150, 0xbfb8aa3b, v182
    v_mul_f32 v151, 0xbfb8aa3b, v183
    v_mul_f32 v152, 0xbfb8aa3b, v184
    v_mul_f32 v153, 0xbfb8aa3b, v185
    v_exp_f32 v148, v148
    v_exp_f32 v149, v149
    v_exp_f32 v150, v150
    v_exp_f32 v151, v151
    v_exp_f32 v152, v152
    v_exp_f32 v153, v153
    v_add_f32 v148, 1.0, v148
    v_add_f32 v149, 1.0, v149
    v_add_f32 v150, 1.0, v150
    v_add_f32 v151, 1.0, v151
    v_add_f32 v152, 1.0, v152
    v_add_f32 v153, 1.0, v153
    v_rcp_f32 v148, v148
    v_rcp_f32 v149, v149
    v_rcp_f32 v150, v150
    v_rcp_f32 v151, v151
    v_rcp_f32 v152, v152
    v_rcp_f32 v153, v153
    s_nop 0
    v_mul_f32 v180, v180, v148
    v_mul_f32 v181, v181, v149
    v_mul_f32 v182, v182, v150
    v_mul_f32 v183, v183, v151
    v_mul_f32 v184, v184, v152
    v_mul_f32 v185, v185, v153
    v_lshlrev_b32 v148, 16, v168
    v_and_b32 v149, 0xffff0000, v168
    v_lshlrev_b32 v150, 16, v169
    v_and_b32 v151, 0xffff0000, v169
    v_lshlrev_b32 v152, 16, v170
    v_and_b32 v153, 0xffff0000, v170
    v_lshlrev_b32 v154, 16, v171
    v_and_b32 v155, 0xffff0000, v171
    v_mul_f32 v132, v180, v148
    v_mul_f32 v133, v180, v149
    v_mul_f32 v134, v180, v150
    v_mul_f32 v135, v180, v151
    v_mul_f32 v136, v180, v152
    v_mul_f32 v137, v180, v153
    v_mul_f32 v138, v180, v154
    v_mul_f32 v139, v180, v155
    v_mul_f32 v140, v183, v148
    v_mul_f32 v141, v183, v149
    v_mul_f32 v142, v183, v150
    v_mul_f32 v143, v183, v151
    v_mul_f32 v144, v183, v152
    v_mul_f32 v145, v183, v153
    v_mul_f32 v146, v183, v154
    v_mul_f32 v147, v183, v155
    v_lshlrev_b32 v156, 16, v172
    v_and_b32 v157, 0xffff0000, v172
    v_lshlrev_b32 v158, 16, v173
    v_and_b32 v159, 0xffff0000, v173
    v_lshlrev_b32 v160, 16, v174
    v_and_b32 v161, 0xffff0000, v174
    v_lshlrev_b32 v162, 16, v175
    v_and_b32 v163, 0xffff0000, v175
    v_fmac_f32 v132, v181, v156
    v_fmac_f32 v133, v181, v157
    v_fmac_f32 v134, v181, v158
    v_fmac_f32 v135, v181, v159
    v_fmac_f32 v136, v181, v160
    v_fmac_f32 v137, v181, v161
    v_fmac_f32 v138, v181, v162
    v_fmac_f32 v139, v181, v163
    v_fmac_f32 v140, v184, v156
    v_fmac_f32 v141, v184, v157
    v_fmac_f32 v142, v184, v158
    v_fmac_f32 v143, v184, v159
    v_fmac_f32 v144, v184, v160
    v_fmac_f32 v145, v184, v161
    v_fmac_f32 v146, v184, v162
    v_fmac_f32 v147, v184, v163
    v_lshlrev_b32 v148, 16, v176
    v_and_b32 v149, 0xffff0000, v176
    v_lshlrev_b32 v150, 16, v177
    v_and_b32 v151, 0xffff0000, v177
    v_lshlrev_b32 v152, 16, v178
    v_and_b32 v153, 0xffff0000, v178
    v_lshlrev_b32 v154, 16, v179
    v_and_b32 v155, 0xffff0000, v179
    v_fmac_f32 v132, v182, v148
    v_fmac_f32 v133, v182, v149
    v_fmac_f32 v134, v182, v150
    v_fmac_f32 v135, v182, v151
    v_fmac_f32 v136, v182, v152
    v_fmac_f32 v137, v182, v153
    v_fmac_f32 v138, v182, v154
    v_fmac_f32 v139, v182, v155
    v_fmac_f32 v140, v185, v148
    v_fmac_f32 v141, v185, v149
    v_fmac_f32 v142, v185, v150
    v_fmac_f32 v143, v185, v151
    v_fmac_f32 v144, v185, v152
    v_fmac_f32 v145, v185, v153
    v_fmac_f32 v146, v185, v154
    v_fmac_f32 v147, v185, v155
    s_nop 0
    v_permlane16_swap_b32 v132, v140
    v_permlane16_swap_b32 v133, v141
    v_permlane16_swap_b32 v134, v142
    v_permlane16_swap_b32 v135, v143
    v_permlane16_swap_b32 v136, v144
    v_permlane16_swap_b32 v137, v145
    v_permlane16_swap_b32 v138, v146
    v_permlane16_swap_b32 v139, v147
    v_add_f32 v132, v132, v140
    v_add_f32 v133, v133, v141
    v_add_f32 v134, v134, v142
    v_add_f32 v135, v135, v143
    v_add_f32 v136, v136, v144
    v_add_f32 v137, v137, v145
    v_add_f32 v138, v138, v146
    v_add_f32 v139, v139, v147
    v_permlane32_swap_b32 v132, v136
    v_permlane32_swap_b32 v133, v137
    v_permlane32_swap_b32 v134, v138
    v_permlane32_swap_b32 v135, v139
    s_nop 0
    v_add_f32 v132, v132, v136
    v_add_f32 v133, v133, v137
    v_add_f32 v134, v134, v138
    v_add_f32 v135, v135, v139
    v_add_f32_dpp v132, v132, v132 row_ror:4 row_mask:0xf bank_mask:0xf
    v_add_f32_dpp v133, v133, v133 row_ror:4 row_mask:0xf bank_mask:0xf
    v_add_f32_dpp v134, v134, v134 row_ror:4 row_mask:0xf bank_mask:0xf
    v_add_f32_dpp v135, v135, v135 row_ror:4 row_mask:0xf bank_mask:0xf
    v_add_f32_dpp v132, v132, v132 row_ror:8 row_mask:0xf bank_mask:0xf
    v_add_f32_dpp v133, v133, v133 row_ror:8 row_mask:0xf bank_mask:0xf
    v_add_f32_dpp v134, v134, v134 row_ror:8 row_mask:0xf bank_mask:0xf
    v_add_f32_dpp v135, v135, v135 row_ror:8 row_mask:0xf bank_mask:0xf
    v_and_b32 v8, 3, v0
    v_lshlrev_b32 v8, 5, v8
    v_and_b32 v9, 16, v0
    v_lshl_add_u32 v8, v9, 3, v8
    v_lshl_add_u32 v8, v5, 4, v8
    s_mov_b32 exec_lo, 0x000f000f
    s_mov_b32 exec_hi, 0x000f000f
    buffer_store_dwordx4 v[132:135], v8, s[4:7], s98 offen sc1
    s_mov_b64 exec, -1
L_side_done:
    v_lshlrev_b32 v224, 16, v48
    v_and_b32 v225, 0xffff0000, v48
    v_lshlrev_b32 v240, 16, v56
    v_and_b32 v241, 0xffff0000, v56
    v_lshlrev_b32 v226, 16, v49
    v_and_b32 v227, 0xffff0000, v49
    v_lshlrev_b32 v242, 16, v57
    v_and_b32 v243, 0xffff0000, v57
    v_lshlrev_b32 v228, 16, v50
    v_and_b32 v229, 0xffff0000, v50
    v_lshlrev_b32 v244, 16, v58
    v_and_b32 v245, 0xffff0000, v58
    v_lshlrev_b32 v230, 16, v51
    v_and_b32 v231, 0xffff0000, v51
    v_lshlrev_b32 v246, 16, v59
    v_and_b32 v247, 0xffff0000, v59
    v_lshlrev_b32 v232, 16, v52
    v_and_b32 v233, 0xffff0000, v52
    v_lshlrev_b32 v248, 16, v60
    v_and_b32 v249, 0xffff0000, v60
    v_lshlrev_b32 v234, 16, v53
    v_and_b32 v235, 0xffff0000, v53
    v_lshlrev_b32 v250, 16, v61
    v_and_b32 v251, 0xffff0000, v61
    v_lshlrev_b32 v236, 16, v54
    v_and_b32 v237, 0xffff0000, v54
    v_lshlrev_b32 v252, 16, v62
    v_and_b32 v253, 0xffff0000, v62
    v_lshlrev_b32 v238, 16, v55
    v_and_b32 v239, 0xffff0000, v55
    v_lshlrev_b32 v254, 16, v63
    v_and_b32 v255, 0xffff0000, v63
    v_mov_b32 v52, 0xbfb8aa3b
    v_mov_b32 v54, 1.0
    v_mov_b32 v55, 0x3fa20000
    v_lshlrev_b32 v8, 1, v2
    s_waitcnt lgkmcnt(0)
    s_barrier
    ds_read_b128 v[48:51], v10 offset:32
    s_cmp_lg_u32 s60, 0
    s_cbranch_scc1 L_notb
    s_mov_b32 s72, 0x170c000
    buffer_load_dwordx4 v[56:59], v8, s[4:7], s72 offen sc1
    buffer_load_dwordx4 v[60:63], v8, s[4:7], s72 offen offset:16 sc1
L_notb:
    s_cmp_lg_u32 s3, 0
    s_cbranch_scc1 L_notb2
    s_add_u32 s70, s69, 0
    buffer_store_dwordx4 v[152:155], v2, s[4:7], s70 offen sc1
    s_add_u32 s70, s69, 6144
    buffer_store_dwordx4 v[156:159], v2, s[4:7], s70 offen sc1
    s_add_u32 s70, s69, 12288
    buffer_store_dwordx4 v[160:163], v2, s[4:7], s70 offen sc1
    s_add_u32 s70, s69, 18432
    buffer_store_dwordx4 v[164:167], v2, s[4:7], s70 offen sc1
    s_add_u32 s70, s69, 24576
    buffer_store_dwordx4 v[168:171], v2, s[4:7], s70 offen sc1
    s_add_u32 s70, s69, 30720
    buffer_store_dwordx4 v[172:175], v2, s[4:7], s70 offen sc1
    s_add_u32 s70, s69, 2048
    buffer_store_dwordx4 v[176:179], v2, s[4:7], s70 offen sc1
    s_add_u32 s70, s69, 8192
    buffer_store_dwordx4 v[180:183], v2, s[4:7], s70 offen sc1
    s_add_u32 s70, s69, 14336
    buffer_store_dwordx4 v[184:187], v2, s[4:7], s70 offen sc1
    s_add_u32 s70, s69, 20480
    buffer_store_dwordx4 v[188:191], v2, s[4:7], s70 offen sc1
    s_add_u32 s70, s69, 26624
    buffer_store_dwordx4 v[192:195], v2, s[4:7], s70 offen sc1
    s_add_u32 s70, s69, 32768
    buffer_store_dwordx4 v[196:199], v2, s[4:7], s70 offen sc1
    s_add_u32 s70, s69, 4096
    buffer_store_dwordx4 v[200:203], v2, s[4:7], s70 offen sc1
    s_add_u32 s70, s69, 10240
    buffer_store_dwordx4 v[204:207], v2, s[4:7], s70 offen sc1
    s_add_u32 s70, s69, 16384
    buffer_store_dwordx4 v[208:211], v2, s[4:7], s70 offen sc1
    s_add_u32 s70, s69, 22528
    buffer_store_dwordx4 v[212:215], v2, s[4:7], s70 offen sc1
    s_add_u32 s70, s69, 28672
    buffer_store_dwordx4 v[216:219], v2, s[4:7], s70 offen sc1
    s_add_u32 s70, s69, 34816
    buffer_store_dwordx4 v[220:223], v2, s[4:7], s70 offen sc1
L_notb2:
    s_mov_b32 s20, s48
    s_and_b32 s21, s49, 0xffff
    s_mov_b32 s22, 0x480000
    s_mov_b32 s23, 0x20000
    s_waitcnt lgkmcnt(0)
    v_readfirstlane_b32 s61, v50
    v_pk_mul_f32 v[224:225], v[224:225], v[48:49] op_sel:[0,1] op_sel_hi:[1,1]
    v_pk_mul_f32 v[226:227], v[226:227], v[48:49] op_sel:[0,1] op_sel_hi:[1,1]
    v_pk_mul_f32 v[228:229], v[228:229], v[48:49] op_sel:[0,1] op_sel_hi:[1,1]
    v_pk_mul_f32 v[230:231], v[230:231], v[48:49] op_sel:[0,1] op_sel_hi:[1,1]
    v_pk_mul_f32 v[232:233], v[232:233], v[48:49] op_sel:[0,1] op_sel_hi:[1,1]
    v_pk_mul_f32 v[234:235], v[234:235], v[48:49] op_sel:[0,1] op_sel_hi:[1,1]
    v_pk_mul_f32 v[236:237], v[236:237], v[48:49] op_sel:[0,1] op_sel_hi:[1,1]
    v_pk_mul_f32 v[238:239], v[238:239], v[48:49] op_sel:[0,1] op_sel_hi:[1,1]
    v_pk_fma_f32 v[240:241], v[224:225], v[48:49], v[240:241] op_sel_hi:[1,0,1]
    v_pk_fma_f32 v[242:243], v[226:227], v[48:49], v[242:243] op_sel_hi:[1,0,1]
    v_pk_fma_f32 v[244:245], v[228:229], v[48:49], v[244:245] op_sel_hi:[1,0,1]
    v_pk_fma_f32 v[246:247], v[230:231], v[48:49], v[246:247] op_sel_hi:[1,0,1]
    v_pk_fma_f32 v[248:249], v[232:233], v[48:49], v[248:249] op_sel_hi:[1,0,1]
    v_pk_fma_f32 v[250:251], v[234:235], v[48:49], v[250:251] op_sel_hi:[1,0,1]
    v_pk_fma_f32 v[252:253], v[236:237], v[48:49], v[252:253] op_sel_hi:[1,0,1]
    v_pk_fma_f32 v[254:255], v[238:239], v[48:49], v[254:255] op_sel_hi:[1,0,1]
    v_pk_fma_f32 v[64:65], v[64:65], v[224:225], v[240:241]
    v_pk_fma_f32 v[66:67], v[66:67], v[226:227], v[242:243]
    v_pk_fma_f32 v[68:69], v[68:69], v[228:229], v[244:245]
    v_pk_fma_f32 v[70:71], v[70:71], v[230:231], v[246:247]
    v_pk_mul_f32 v[16:17], v[64:65], v[52:53] op_sel_hi:[1,0]
    v_pk_mul_f32 v[18:19], v[66:67], v[52:53] op_sel_hi:[1,0]
    v_pk_mul_f32 v[20:21], v[68:69], v[52:53] op_sel_hi:[1,0]
    v_pk_mul_f32 v[22:23], v[70:71], v[52:53] op_sel_hi:[1,0]
    v_exp_f32 v16, v16
    v_pk_fma_f32 v[80:81], v[80:81], v[224:225], v[240:241]
    v_exp_f32 v17, v17
    v_pk_fma_f32 v[82:83], v[82:83], v[226:227], v[242:243]
    v_exp_f32 v18, v18
    v_pk_fma_f32 v[84:85], v[84:85], v[228:229], v[244:245]
    v_exp_f32 v19, v19
    v_pk_fma_f32 v[86:87], v[86:87], v[230:231], v[246:247]
    v_exp_f32 v20, v20
    v_pk_mul_f32 v[24:25], v[80:81], v[52:53] op_sel_hi:[1,0]
    v_exp_f32 v21, v21
    v_pk_mul_f32 v[26:27], v[82:83], v[52:53] op_sel_hi:[1,0]
    v_exp_f32 v22, v22
    v_pk_mul_f32 v[28:29], v[84:85], v[52:53] op_sel_hi:[1,0]
    v_exp_f32 v23, v23
    v_pk_mul_f32 v[30:31], v[86:87], v[52:53] op_sel_hi:[1,0]
    v_exp_f32 v24, v24
    v_pk_add_f32 v[16:17], v[16:17], v[54:55] op_sel_hi:[1,0]
    v_exp_f32 v25, v25
    v_pk_add_f32 v[18:19], v[18:19], v[54:55] op_sel_hi:[1,0]
    v_exp_f32 v26, v26
    v_pk_add_f32 v[20:21], v[20:21], v[54:55] op_sel_hi:[1,0]
    v_exp_f32 v27, v27
    v_pk_add_f32 v[22:23], v[22:23], v[54:55] op_sel_hi:[1,0]
    v_exp_f32 v28, v28
    v_pk_fma_f32 v[96:97], v[96:97], v[224:225], v[240:241]
    v_exp_f32 v29, v29
    v_pk_fma_f32 v[98:99], v[98:99], v[226:227], v[242:243]
    v_exp_f32 v30, v30
    v_pk_fma_f32 v[100:101], v[100:101], v[228:229], v[244:245]
    v_exp_f32 v31, v31
    v_pk_fma_f32 v[102:103], v[102:103], v[230:231], v[246:247]
    v_rcp_f32 v16, v16
    v_pk_mul_f32 v[32:33], v[96:97], v[52:53] op_sel_hi:[1,0]
    v_rcp_f32 v17, v17
    v_pk_mul_f32 v[34:35], v[98:99], v[52:53] op_sel_hi:[1,0]
    v_rcp_f32 v18, v18
    v_pk_mul_f32 v[36:37], v[100:101], v[52:53] op_sel_hi:[1,0]
    v_rcp_f32 v19, v19
    v_pk_mul_f32 v[38:39], v[102:103], v[52:53] op_sel_hi:[1,0]
    v_rcp_f32 v20, v20
    v_pk_add_f32 v[24:25], v[24:25], v[54:55] op_sel_hi:[1,0]
    v_rcp_f32 v21, v21
    v_pk_add_f32 v[26:27], v[26:27], v[54:55] op_sel_hi:[1,0]
    v_rcp_f32 v22, v22
    v_pk_add_f32 v[28:29], v[28:29], v[54:55] op_sel_hi:[1,0]
    v_rcp_f32 v23, v23
    v_pk_add_f32 v[30:31], v[30:31], v[54:55] op_sel_hi:[1,0]
    v_exp_f32 v32, v32
    v_pk_mul_f32 v[64:65], v[64:65], v[16:17]
    v_exp_f32 v33, v33
    v_pk_mul_f32 v[66:67], v[66:67], v[18:19]
    v_exp_f32 v34, v34
    v_pk_mul_f32 v[68:69], v[68:69], v[20:21]
    v_exp_f32 v35, v35
    v_pk_mul_f32 v[70:71], v[70:71], v[22:23]
    v_exp_f32 v36, v36
    v_pk_fma_f32 v[112:113], v[112:113], v[224:225], v[240:241]
    v_exp_f32 v37, v37
    v_pk_fma_f32 v[114:115], v[114:115], v[226:227], v[242:243]
    v_exp_f32 v38, v38
    v_pk_fma_f32 v[116:117], v[116:117], v[228:229], v[244:245]
    v_exp_f32 v39, v39
    v_pk_fma_f32 v[118:119], v[118:119], v[230:231], v[246:247]
    v_rcp_f32 v24, v24
    v_pk_mul_f32 v[40:41], v[112:113], v[52:53] op_sel_hi:[1,0]
    v_rcp_f32 v25, v25
    v_pk_mul_f32 v[42:43], v[114:115], v[52:53] op_sel_hi:[1,0]
    v_rcp_f32 v26, v26
    v_pk_mul_f32 v[44:45], v[116:117], v[52:53] op_sel_hi:[1,0]
    v_rcp_f32 v27, v27
    v_pk_mul_f32 v[46:47], v[118:119], v[52:53] op_sel_hi:[1,0]
    v_rcp_f32 v28, v28
    v_pk_add_f32 v[32:33], v[32:33], v[54:55] op_sel_hi:[1,0]
    v_rcp_f32 v29, v29
    v_pk_add_f32 v[34:35], v[34:35], v[54:55] op_sel_hi:[1,0]
    v_rcp_f32 v30, v30
    v_pk_add_f32 v[36:37], v[36:37], v[54:55] op_sel_hi:[1,0]
    v_rcp_f32 v31, v31
    v_pk_add_f32 v[38:39], v[38:39], v[54:55] op_sel_hi:[1,0]
    v_exp_f32 v40, v40
    v_pk_mul_f32 v[80:81], v[80:81], v[24:25]
    v_exp_f32 v41, v41
    v_pk_mul_f32 v[82:83], v[82:83], v[26:27]
    v_exp_f32 v42, v42
    v_pk_mul_f32 v[84:85], v[84:85], v[28:29]
    v_exp_f32 v43, v43
    v_pk_mul_f32 v[86:87], v[86:87], v[30:31]
    v_exp_f32 v44, v44
    v_exp_f32 v45, v45
    v_exp_f32 v46, v46
    v_exp_f32 v47, v47
    v_rcp_f32 v32, v32
    v_pk_add_f32 v[40:41], v[40:41], v[54:55] op_sel_hi:[1,0]
    v_rcp_f32 v33, v33
    v_pk_add_f32 v[42:43], v[42:43], v[54:55] op_sel_hi:[1,0]
    v_rcp_f32 v34, v34
    v_pk_add_f32 v[44:45], v[44:45], v[54:55] op_sel_hi:[1,0]
    v_rcp_f32 v35, v35
    v_pk_add_f32 v[46:47], v[46:47], v[54:55] op_sel_hi:[1,0]
    v_rcp_f32 v36, v36
    v_rcp_f32 v37, v37
    v_rcp_f32 v38, v38
    v_rcp_f32 v39, v39
    v_rcp_f32 v40, v40
    v_pk_mul_f32 v[96:97], v[96:97], v[32:33]
    v_rcp_f32 v41, v41
    v_pk_mul_f32 v[98:99], v[98:99], v[34:35]
    v_rcp_f32 v42, v42
    v_pk_mul_f32 v[100:101], v[100:101], v[36:37]
    v_rcp_f32 v43, v43
    v_pk_mul_f32 v[102:103], v[102:103], v[38:39]
    v_rcp_f32 v44, v44
    v_rcp_f32 v45, v45
    v_rcp_f32 v46, v46
    v_rcp_f32 v47, v47
    s_nop 0
    v_pk_mul_f32 v[112:113], v[112:113], v[40:41]
    v_pk_mul_f32 v[114:115], v[114:115], v[42:43]
    v_pk_mul_f32 v[116:117], v[116:117], v[44:45]
    v_pk_mul_f32 v[118:119], v[118:119], v[46:47]
    v_pk_fma_f32 v[16:17], v[80:81], s[34:35], v[112:113] op_sel:[0,1,0] op_sel_hi:[1,1,1] neg_lo:[0,1,0] neg_hi:[0,1,0]
    v_pk_fma_f32 v[18:19], v[82:83], s[34:35], v[114:115] op_sel:[0,1,0] op_sel_hi:[1,1,1] neg_lo:[0,1,0] neg_hi:[0,1,0]
    v_pk_fma_f32 v[20:21], v[84:85], s[34:35], v[116:117] op_sel:[0,1,0] op_sel_hi:[1,1,1] neg_lo:[0,1,0] neg_hi:[0,1,0]
    v_pk_fma_f32 v[22:23], v[86:87], s[34:35], v[118:119] op_sel:[0,1,0] op_sel_hi:[1,1,1] neg_lo:[0,1,0] neg_hi:[0,1,0]
    v_pk_fma_f32 v[24:25], v[64:65], s[34:35], v[96:97] op_sel:[0,1,0] op_sel_hi:[1,1,1] neg_lo:[0,1,0] neg_hi:[0,1,0]
    v_pk_fma_f32 v[26:27], v[66:67], s[34:35], v[98:99] op_sel:[0,1,0] op_sel_hi:[1,1,1] neg_lo:[0,1,0] neg_hi:[0,1,0]
    v_pk_fma_f32 v[28:29], v[68:69], s[34:35], v[100:101] op_sel:[0,1,0] op_sel_hi:[1,1,1] neg_lo:[0,1,0] neg_hi:[0,1,0]
    v_pk_fma_f32 v[30:31], v[70:71], s[34:35], v[102:103] op_sel:[0,1,0] op_sel_hi:[1,1,1] neg_lo:[0,1,0] neg_hi:[0,1,0]
    v_pk_fma_f32 v[32:33], v[24:25], s[32:33], v[16:17] op_sel:[0,0,0] op_sel_hi:[1,0,1]
    v_pk_fma_f32 v[34:35], v[26:27], s[32:33], v[18:19] op_sel:[0,0,0] op_sel_hi:[1,0,1]
    v_pk_fma_f32 v[36:37], v[28:29], s[32:33], v[20:21] op_sel:[0,0,0] op_sel_hi:[1,0,1]
    v_pk_fma_f32 v[38:39], v[30:31], s[32:33], v[22:23] op_sel:[0,0,0] op_sel_hi:[1,0,1]
    v_pk_fma_f32 v[40:41], v[24:25], s[32:33], v[16:17] op_sel:[0,0,0] op_sel_hi:[1,0,1] neg_lo:[0,1,0] neg_hi:[0,1,0]
    v_pk_fma_f32 v[42:43], v[26:27], s[32:33], v[18:19] op_sel:[0,0,0] op_sel_hi:[1,0,1] neg_lo:[0,1,0] neg_hi:[0,1,0]
    v_pk_fma_f32 v[44:45], v[28:29], s[32:33], v[20:21] op_sel:[0,0,0] op_sel_hi:[1,0,1] neg_lo:[0,1,0] neg_hi:[0,1,0]
    v_pk_fma_f32 v[46:47], v[30:31], s[32:33], v[22:23] op_sel:[0,0,0] op_sel_hi:[1,0,1] neg_lo:[0,1,0] neg_hi:[0,1,0]
    v_cvt_pk_bf16_f32 v128, v32, v33
    v_cvt_pk_bf16_f32 v129, v34, v35
    v_cvt_pk_bf16_f32 v130, v36, v37
    v_cvt_pk_bf16_f32 v131, v38, v39
    s_add_u32 s72, s79, 0x0
    buffer_store_dwordx4 v[128:131], v4, s[4:7], s72 offen sc1
    v_cvt_pk_bf16_f32 v132, v40, v41
    v_cvt_pk_bf16_f32 v133, v42, v43
    v_cvt_pk_bf16_f32 v134, v44, v45
    v_cvt_pk_bf16_f32 v135, v46, v47
    s_add_u32 s72, s79, 0x10000
    buffer_store_dwordx4 v[132:135], v4, s[4:7], s72 offen sc1
    v_pk_fma_f32 v[16:17], v[80:81], s[34:35], v[112:113] op_sel:[0,0,0] op_sel_hi:[1,0,1] neg_lo:[0,1,0] neg_hi:[0,1,0]
    v_pk_fma_f32 v[18:19], v[82:83], s[34:35], v[114:115] op_sel:[0,0,0] op_sel_hi:[1,0,1] neg_lo:[0,1,0] neg_hi:[0,1,0]
    v_pk_fma_f32 v[20:21], v[84:85], s[34:35], v[116:117] op_sel:[0,0,0] op_sel_hi:[1,0,1] neg_lo:[0,1,0] neg_hi:[0,1,0]
    v_pk_fma_f32 v[22:23], v[86:87], s[34:35], v[118:119] op_sel:[0,0,0] op_sel_hi:[1,0,1] neg_lo:[0,1,0] neg_hi:[0,1,0]
    v_pk_fma_f32 v[24:25], v[64:65], s[34:35], v[96:97] op_sel:[0,0,0] op_sel_hi:[1,0,1] neg_lo:[0,1,0] neg_hi:[0,1,0]
    v_pk_fma_f32 v[26:27], v[66:67], s[34:35], v[98:99] op_sel:[0,0,0] op_sel_hi:[1,0,1] neg_lo:[0,1,0] neg_hi:[0,1,0]
    v_pk_fma_f32 v[28:29], v[68:69], s[34:35], v[100:101] op_sel:[0,0,0] op_sel_hi:[1,0,1] neg_lo:[0,1,0] neg_hi:[0,1,0]
    v_pk_fma_f32 v[30:31], v[70:71], s[34:35], v[102:103] op_sel:[0,0,0] op_sel_hi:[1,0,1] neg_lo:[0,1,0] neg_hi:[0,1,0]
    v_pk_fma_f32 v[32:33], v[24:25], s[32:33], v[16:17] op_sel:[0,1,0] op_sel_hi:[1,1,1]
    v_pk_fma_f32 v[34:35], v[26:27], s[32:33], v[18:19] op_sel:[0,1,0] op_sel_hi:[1,1,1]
    v_pk_fma_f32 v[36:37], v[28:29], s[32:33], v[20:21] op_sel:[0,1,0] op_sel_hi:[1,1,1]
    v_pk_fma_f32 v[38:39], v[30:31], s[32:33], v[22:23] op_sel:[0,1,0] op_sel_hi:[1,1,1]
    v_pk_fma_f32 v[40:41], v[24:25], s[32:33], v[16:17] op_sel:[0,1,0] op_sel_hi:[1,1,1] neg_lo:[0,1,0] neg_hi:[0,1,0]
    v_pk_fma_f32 v[42:43], v[26:27], s[32:33], v[18:19] op_sel:[0,1,0] op_sel_hi:[1,1,1] neg_lo:[0,1,0] neg_hi:[0,1,0]
    v_pk_fma_f32 v[44:45], v[28:29], s[32:33], v[20:21] op_sel:[0,1,0] op_sel_hi:[1,1,1] neg_lo:[0,1,0] neg_hi:[0,1,0]
    v_pk_fma_f32 v[46:47], v[30:31], s[32:33], v[22:23] op_sel:[0,1,0] op_sel_hi:[1,1,1] neg_lo:[0,1,0] neg_hi:[0,1,0]
    v_cvt_pk_bf16_f32 v136, v32, v33
    v_cvt_pk_bf16_f32 v137, v34, v35
    v_cvt_pk_bf16_f32 v138, v36, v37
    v_cvt_pk_bf16_f32 v139, v38, v39
    s_add_u32 s72, s79, 0x20000
    buffer_store_dwordx4 v[136:139], v4, s[4:7], s72 offen sc1
    v_cvt_pk_bf16_f32 v140, v40, v41
    v_cvt_pk_bf16_f32 v141, v42, v43
    v_cvt_pk_bf16_f32 v142, v44, v45
    v_cvt_pk_bf16_f32 v143, v46, v47
    s_add_u32 s72, s79, 0x30000
    buffer_store_dwordx4 v[140:143], v4, s[4:7], s72 offen sc1
    v_pk_fma_f32 v[16:17], v[80:81], s[36:37], v[112:113] op_sel:[0,1,0] op_sel_hi:[1,1,1] neg_lo:[0,1,0] neg_hi:[0,1,0]
    v_pk_fma_f32 v[18:19], v[82:83], s[36:37], v[114:115] op_sel:[0,1,0] op_sel_hi:[1,1,1] neg_lo:[0,1,0] neg_hi:[0,1,0]
    v_pk_fma_f32 v[20:21], v[84:85], s[36:37], v[116:117] op_sel:[0,1,0] op_sel_hi:[1,1,1] neg_lo:[0,1,0] neg_hi:[0,1,0]
    v_pk_fma_f32 v[22:23], v[86:87], s[36:37], v[118:119] op_sel:[0,1,0] op_sel_hi:[1,1,1] neg_lo:[0,1,0] neg_hi:[0,1,0]
    v_pk_mul_f32 v[24:25], v[64:65], s[36:37] op_sel:[0,0] op_sel_hi:[1,0]
    v_pk_mul_f32 v[26:27], v[66:67], s[36:37] op_sel:[0,0] op_sel_hi:[1,0]
    v_pk_mul_f32 v[28:29], v[68:69], s[36:37] op_sel:[0,0] op_sel_hi:[1,0]
    v_pk_mul_f32 v[30:31], v[70:71], s[36:37] op_sel:[0,0] op_sel_hi:[1,0]
    v_fmac_f32_dpp v16, v112, v55 row_shr:1 row_mask:0xf bank_mask:0xf bound_ctrl:0
    v_fmac_f32_dpp v17, v113, v55 row_shr:1 row_mask:0xf bank_mask:0xf bound_ctrl:0
    v_fmac_f32_dpp v18, v114, v55 row_shr:1 row_mask:0xf bank_mask:0xf bound_ctrl:0
    v_fmac_f32_dpp v19, v115, v55 row_shr:1 row_mask:0xf bank_mask:0xf bound_ctrl:0
    v_fmac_f32_dpp v20, v116, v55 row_shr:1 row_mask:0xf bank_mask:0xf bound_ctrl:0
    v_fmac_f32_dpp v21, v117, v55 row_shr:1 row_mask:0xf bank_mask:0xf bound_ctrl:0
    v_fmac_f32_dpp v22, v118, v55 row_shr:1 row_mask:0xf bank_mask:0xf bound_ctrl:0
    v_fmac_f32_dpp v23, v119, v55 row_shr:1 row_mask:0xf bank_mask:0xf bound_ctrl:0
    v_pk_fma_f32 v[24:25], v[96:97], s[36:37], v[24:25] op_sel:[0,1,0] op_sel_hi:[1,1,1] neg_lo:[0,1,0] neg_hi:[0,1,0]
    v_pk_fma_f32 v[26:27], v[98:99], s[36:37], v[26:27] op_sel:[0,1,0] op_sel_hi:[1,1,1] neg_lo:[0,1,0] neg_hi:[0,1,0]
    v_pk_fma_f32 v[28:29], v[100:101], s[36:37], v[28:29] op_sel:[0,1,0] op_sel_hi:[1,1,1] neg_lo:[0,1,0] neg_hi:[0,1,0]
    v_pk_fma_f32 v[30:31], v[102:103], s[36:37], v[30:31] op_sel:[0,1,0] op_sel_hi:[1,1,1] neg_lo:[0,1,0] neg_hi:[0,1,0]
    v_cvt_pk_bf16_f32 v144, v16, v17
    v_cvt_pk_bf16_f32 v145, v18, v19
    v_cvt_pk_bf16_f32 v146, v20, v21
    v_cvt_pk_bf16_f32 v147, v22, v23
    s_add_u32 s72, s79, 0x40000
    buffer_store_dwordx4 v[144:147], v4, s[4:7], s72 offen sc1
    v_add_f32_dpp v24, v64, v24 row_shl:1 row_mask:0xf bank_mask:0xf bound_ctrl:0
    v_add_f32_dpp v25, v65, v25 row_shl:1 row_mask:0xf bank_mask:0xf bound_ctrl:0
    v_add_f32_dpp v26, v66, v26 row_shl:1 row_mask:0xf bank_mask:0xf bound_ctrl:0
    v_add_f32_dpp v27, v67, v27 row_shl:1 row_mask:0xf bank_mask:0xf bound_ctrl:0
    v_add_f32_dpp v28, v68, v28 row_shl:1 row_mask:0xf bank_mask:0xf bound_ctrl:0
    v_add_f32_dpp v29, v69, v29 row_shl:1 row_mask:0xf bank_mask:0xf bound_ctrl:0
    v_add_f32_dpp v30, v70, v30 row_shl:1 row_mask:0xf bank_mask:0xf bound_ctrl:0
    v_add_f32_dpp v31, v71, v31 row_shl:1 row_mask:0xf bank_mask:0xf bound_ctrl:0
    v_cvt_pk_bf16_f32 v148, v24, v25
    v_cvt_pk_bf16_f32 v149, v26, v27
    v_cvt_pk_bf16_f32 v150, v28, v29
    v_cvt_pk_bf16_f32 v151, v30, v31
    s_add_u32 s72, s79, 0x50000
    buffer_store_dwordx4 v[148:151], v4, s[4:7], s72 offen sc1
    s_waitcnt vmcnt(0)
    s_barrier
    s_cmp_lg_u32 s3, 3
    s_cbranch_scc1 L_nof0
    s_mov_b64 exec, 3
    buffer_store_dwordx2 v[50:51], v12, s[4:7], s86 offen sc0 sc1
    s_mov_b64 exec, -1
L_nof0:
    s_cmp_lg_u32 s60, 0
    s_cbranch_scc1 L_haveid
    s_mov_b32 s71, 100000
L_tchk:
    v_lshlrev_b32 v9, 2, v0
    v_and_b32 v8, 0xfffff0ff, v56
    v_xor_b32 v8, v8, v9
    v_xor_b32 v10, s61, v57
    v_or_b32 v10, v10, v8
    v_add_u32 v9, 1, v9
    v_and_b32 v8, 0xfffff0ff, v58
    v_xor_b32 v8, v8, v9
    v_xor_b32 v53, s61, v59
    v_or3_b32 v10, v10, v8, v53
    v_add_u32 v9, 1, v9
    v_and_b32 v8, 0xfffff0ff, v60
    v_xor_b32 v8, v8, v9
    v_xor_b32 v53, s61, v61
    v_or3_b32 v10, v10, v8, v53
    v_add_u32 v9, 1, v9
    v_and_b32 v8, 0xfffff0ff, v62
    v_xor_b32 v8, v8, v9
    v_xor_b32 v53, s61, v63
    v_or3_b32 v10, v10, v8, v53
    v_cmp_ne_u32 vcc, 0, v10
    s_nop 1
    s_cmp_lg_u64 vcc, 0
    s_cbranch_scc1 L_tpoll
L_tok:
    v_cmp_gt_u32 vcc, s97, v56
    v_cmp_gt_u32 s[80:81], s97, v58
    v_cmp_gt_u32 s[82:83], s97, v60
    v_cmp_gt_u32 s[84:85], s97, v62
    s_nop 1
    s_bcnt1_i32_b64 s94, vcc
    s_bcnt1_i32_b64 s72, s[80:81]
    s_add_u32 s94, s94, s72
    s_bcnt1_i32_b64 s72, s[82:83]
    s_add_u32 s94, s94, s72
    s_bcnt1_i32_b64 s72, s[84:85]
    s_add_u32 s94, s94, s72
    s_and_b32 s94, s94, 255
    s_lshr_b32 s56, s94, 3
    s_and_b32 s56, s56, 12
    s_and_b32 s73, s94, 3
    s_add_u32 s56, s56, s73
    s_lshr_b32 s57, s94, 4
    s_and_b32 s57, s57, 8
    s_bfe_u32 s73, s94, 0x30002
    s_add_u32 s57, s57, s73
    s_lshr_b32 s58, s56, 3
    s_and_b32 s59, s56, 7
    s_lshl_b32 s59, s59, 3
    s_lshl_b32 s67, s58, 22
    s_lshl_b32 s73, s57, 18
    s_add_u32 s67, s67, s73
    s_lshl_b32 s73, s59, 7
    s_add_u32 s67, s67, s73
    s_lshl_b32 s73, s3, 8
    s_add_u32 s67, s67, s73
    v_lshrrev_b32 v8, 4, v0
    s_and_b32 s72, s56, 7
    v_add_u32 v9, s72, v8
    v_subrev_u32 v9, 1, v9
    v_med3_i32 v9, v9, 0, 7
    s_and_b32 s72, s56, 8
    v_add_u32 v9, s72, v9
    s_add_u32 s72, s57, 16
    v_mov_b32 v8, s72
    v_cmp_gt_u32 vcc, 48, v0
    s_nop 1
    v_cndmask_b32 v9, v8, v9, vcc
    v_lshlrev_b32 v9, 8, v9
    v_lshl_add_u32 v1, v6, 3, v9
L_haveid:
    v_pk_fma_f32 v[72:73], v[72:73], v[232:233], v[248:249]
    v_pk_fma_f32 v[74:75], v[74:75], v[234:235], v[250:251]
    v_pk_fma_f32 v[76:77], v[76:77], v[236:237], v[252:253]
    v_pk_fma_f32 v[78:79], v[78:79], v[238:239], v[254:255]
    v_pk_mul_f32 v[16:17], v[72:73], v[52:53] op_sel_hi:[1,0]
    v_pk_mul_f32 v[18:19], v[74:75], v[52:53] op_sel_hi:[1,0]
    v_pk_mul_f32 v[20:21], v[76:77], v[52:53] op_sel_hi:[1,0]
    v_pk_mul_f32 v[22:23], v[78:79], v[52:53] op_sel_hi:[1,0]
    v_exp_f32 v16, v16
    v_pk_fma_f32 v[88:89], v[88:89], v[232:233], v[248:249]
    v_exp_f32 v17, v17
    v_pk_fma_f32 v[90:91], v[90:91], v[234:235], v[250:251]
    v_exp_f32 v18, v18
    v_pk_fma_f32 v[92:93], v[92:93], v[236:237], v[252:253]
    v_exp_f32 v19, v19
    v_pk_fma_f32 v[94:95], v[94:95], v[238:239], v[254:255]
    v_exp_f32 v20, v20
    v_pk_mul_f32 v[24:25], v[88:89], v[52:53] op_sel_hi:[1,0]
    v_exp_f32 v21, v21
    v_pk_mul_f32 v[26:27], v[90:91], v[52:53] op_sel_hi:[1,0]
    v_exp_f32 v22, v22
    v_pk_mul_f32 v[28:29], v[92:93], v[52:53] op_sel_hi:[1,0]
    v_exp_f32 v23, v23
    v_pk_mul_f32 v[30:31], v[94:95], v[52:53] op_sel_hi:[1,0]
    v_exp_f32 v24, v24
    v_pk_add_f32 v[16:17], v[16:17], v[54:55] op_sel_hi:[1,0]
    v_exp_f32 v25, v25
    v_pk_add_f32 v[18:19], v[18:19], v[54:55] op_sel_hi:[1,0]
    v_exp_f32 v26, v26
    v_pk_add_f32 v[20:21], v[20:21], v[54:55] op_sel_hi:[1,0]
    v_exp_f32 v27, v27
    v_pk_add_f32 v[22:23], v[22:23], v[54:55] op_sel_hi:[1,0]
    v_exp_f32 v28, v28
    v_pk_fma_f32 v[104:105], v[104:105], v[232:233], v[248:249]
    v_exp_f32 v29, v29
    v_pk_fma_f32 v[106:107], v[106:107], v[234:235], v[250:251]
    v_exp_f32 v30, v30
    v_pk_fma_f32 v[108:109], v[108:109], v[236:237], v[252:253]
    v_exp_f32 v31, v31
    v_pk_fma_f32 v[110:111], v[110:111], v[238:239], v[254:255]
    v_rcp_f32 v16, v16
    v_pk_mul_f32 v[32:33], v[104:105], v[52:53] op_sel_hi:[1,0]
    v_rcp_f32 v17, v17
    v_pk_mul_f32 v[34:35], v[106:107], v[52:53] op_sel_hi:[1,0]
    v_rcp_f32 v18, v18
    v_pk_mul_f32 v[36:37], v[108:109], v[52:53] op_sel_hi:[1,0]
    v_rcp_f32 v19, v19
    v_pk_mul_f32 v[38:39], v[110:111], v[52:53] op_sel_hi:[1,0]
    v_rcp_f32 v20, v20
    v_pk_add_f32 v[24:25], v[24:25], v[54:55] op_sel_hi:[1,0]
    v_rcp_f32 v21, v21
    v_pk_add_f32 v[26:27], v[26:27], v[54:55] op_sel_hi:[1,0]
    v_rcp_f32 v22, v22
    v_pk_add_f32 v[28:29], v[28:29], v[54:55] op_sel_hi:[1,0]
    v_rcp_f32 v23, v23
    v_pk_add_f32 v[30:31], v[30:31], v[54:55] op_sel_hi:[1,0]
    v_exp_f32 v32, v32
    v_pk_mul_f32 v[72:73], v[72:73], v[16:17]
    v_exp_f32 v33, v33
    v_pk_mul_f32 v[74:75], v[74:75], v[18:19]
    v_exp_f32 v34, v34
    v_pk_mul_f32 v[76:77], v[76:77], v[20:21]
    v_exp_f32 v35, v35
    v_pk_mul_f32 v[78:79], v[78:79], v[22:23]
    v_exp_f32 v36, v36
    v_pk_fma_f32 v[120:121], v[120:121], v[232:233], v[248:249]
    v_exp_f32 v37, v37
    v_pk_fma_f32 v[122:123], v[122:123], v[234:235], v[250:251]
    v_exp_f32 v38, v38
    v_pk_fma_f32 v[124:125], v[124:125], v[236:237], v[252:253]
    v_exp_f32 v39, v39
    v_pk_fma_f32 v[126:127], v[126:127], v[238:239], v[254:255]
    v_rcp_f32 v24, v24
    v_pk_mul_f32 v[40:41], v[120:121], v[52:53] op_sel_hi:[1,0]
    v_rcp_f32 v25, v25
    v_pk_mul_f32 v[42:43], v[122:123], v[52:53] op_sel_hi:[1,0]
    v_rcp_f32 v26, v26
    v_pk_mul_f32 v[44:45], v[124:125], v[52:53] op_sel_hi:[1,0]
    v_rcp_f32 v27, v27
    v_pk_mul_f32 v[46:47], v[126:127], v[52:53] op_sel_hi:[1,0]
    v_rcp_f32 v28, v28
    v_pk_add_f32 v[32:33], v[32:33], v[54:55] op_sel_hi:[1,0]
    v_rcp_f32 v29, v29
    v_pk_add_f32 v[34:35], v[34:35], v[54:55] op_sel_hi:[1,0]
    v_rcp_f32 v30, v30
    v_pk_add_f32 v[36:37], v[36:37], v[54:55] op_sel_hi:[1,0]
    v_rcp_f32 v31, v31
    v_pk_add_f32 v[38:39], v[38:39], v[54:55] op_sel_hi:[1,0]
    v_exp_f32 v40, v40
    v_pk_mul_f32 v[88:89], v[88:89], v[24:25]
    v_exp_f32 v41, v41
    v_pk_mul_f32 v[90:91], v[90:91], v[26:27]
    v_exp_f32 v42, v42
    v_pk_mul_f32 v[92:93], v[92:93], v[28:29]
    v_exp_f32 v43, v43
    v_pk_mul_f32 v[94:95], v[94:95], v[30:31]
    v_exp_f32 v44, v44
    v_exp_f32 v45, v45
    v_exp_f32 v46, v46
    v_exp_f32 v47, v47
    v_rcp_f32 v32, v32
    v_pk_add_f32 v[40:41], v[40:41], v[54:55] op_sel_hi:[1,0]
    v_rcp_f32 v33, v33
    v_pk_add_f32 v[42:43], v[42:43], v[54:55] op_sel_hi:[1,0]
    v_rcp_f32 v34, v34
    v_pk_add_f32 v[44:45], v[44:45], v[54:55] op_sel_hi:[1,0]
    v_rcp_f32 v35, v35
    v_pk_add_f32 v[46:47], v[46:47], v[54:55] op_sel_hi:[1,0]
    v_rcp_f32 v36, v36
    v_rcp_f32 v37, v37
    v_rcp_f32 v38, v38
    v_rcp_f32 v39, v39
    v_rcp_f32 v40, v40
    v_pk_mul_f32 v[104:105], v[104:105], v[32:33]
    v_rcp_f32 v41, v41
    v_pk_mul_f32 v[106:107], v[106:107], v[34:35]
    v_rcp_f32 v42, v42
    v_pk_mul_f32 v[108:109], v[108:109], v[36:37]
    v_rcp_f32 v43, v43
    v_pk_mul_f32 v[110:111], v[110:111], v[38:39]
    v_rcp_f32 v44, v44
    v_rcp_f32 v45, v45
    v_rcp_f32 v46, v46
    v_rcp_f32 v47, v47
    s_nop 0
    v_pk_mul_f32 v[120:121], v[120:121], v[40:41]
    v_pk_mul_f32 v[122:123], v[122:123], v[42:43]
    v_pk_mul_f32 v[124:125], v[124:125], v[44:45]
    v_pk_mul_f32 v[126:127], v[126:127], v[46:47]
    v_pk_fma_f32 v[16:17], v[88:89], s[34:35], v[120:121] op_sel:[0,1,0] op_sel_hi:[1,1,1] neg_lo:[0,1,0] neg_hi:[0,1,0]
    v_pk_fma_f32 v[18:19], v[90:91], s[34:35], v[122:123] op_sel:[0,1,0] op_sel_hi:[1,1,1] neg_lo:[0,1,0] neg_hi:[0,1,0]
    v_pk_fma_f32 v[20:21], v[92:93], s[34:35], v[124:125] op_sel:[0,1,0] op_sel_hi:[1,1,1] neg_lo:[0,1,0] neg_hi:[0,1,0]
    v_pk_fma_f32 v[22:23], v[94:95], s[34:35], v[126:127] op_sel:[0,1,0] op_sel_hi:[1,1,1] neg_lo:[0,1,0] neg_hi:[0,1,0]
    v_pk_fma_f32 v[24:25], v[72:73], s[34:35], v[104:105] op_sel:[0,1,0] op_sel_hi:[1,1,1] neg_lo:[0,1,0] neg_hi:[0,1,0]
    v_pk_fma_f32 v[26:27], v[74:75], s[34:35], v[106:107] op_sel:[0,1,0] op_sel_hi:[1,1,1] neg_lo:[0,1,0] neg_hi:[0,1,0]
    v_pk_fma_f32 v[28:29], v[76:77], s[34:35], v[108:109] op_sel:[0,1,0] op_sel_hi:[1,1,1] neg_lo:[0,1,0] neg_hi:[0,1,0]
    v_pk_fma_f32 v[30:31], v[78:79], s[34:35], v[110:111] op_sel:[0,1,0] op_sel_hi:[1,1,1] neg_lo:[0,1,0] neg_hi:[0,1,0]
    v_pk_fma_f32 v[32:33], v[24:25], s[32:33], v[16:17] op_sel:[0,0,0] op_sel_hi:[1,0,1]
    v_pk_fma_f32 v[34:35], v[26:27], s[32:33], v[18:19] op_sel:[0,0,0] op_sel_hi:[1,0,1]
    v_pk_fma_f32 v[36:37], v[28:29], s[32:33], v[20:21] op_sel:[0,0,0] op_sel_hi:[1,0,1]
    v_pk_fma_f32 v[38:39], v[30:31], s[32:33], v[22:23] op_sel:[0,0,0] op_sel_hi:[1,0,1]
    v_pk_fma_f32 v[40:41], v[24:25], s[32:33], v[16:17] op_sel:[0,0,0] op_sel_hi:[1,0,1] neg_lo:[0,1,0] neg_hi:[0,1,0]
    v_pk_fma_f32 v[42:43], v[26:27], s[32:33], v[18:19] op_sel:[0,0,0] op_sel_hi:[1,0,1] neg_lo:[0,1,0] neg_hi:[0,1,0]
    v_pk_fma_f32 v[44:45], v[28:29], s[32:33], v[20:21] op_sel:[0,0,0] op_sel_hi:[1,0,1] neg_lo:[0,1,0] neg_hi:[0,1,0]
    v_pk_fma_f32 v[46:47], v[30:31], s[32:33], v[22:23] op_sel:[0,0,0] op_sel_hi:[1,0,1] neg_lo:[0,1,0] neg_hi:[0,1,0]
    v_cvt_pk_bf16_f32 v128, v32, v33
    v_cvt_pk_bf16_f32 v129, v34, v35
    v_cvt_pk_bf16_f32 v130, v36, v37
    v_cvt_pk_bf16_f32 v131, v38, v39
    s_add_u32 s72, s79, 0x300000
    buffer_store_dwordx4 v[128:131], v4, s[4:7], s72 offen sc1
    v_cvt_pk_bf16_f32 v132, v40, v41
    v_cvt_pk_bf16_f32 v133, v42, v43
    v_cvt_pk_bf16_f32 v134, v44, v45
    v_cvt_pk_bf16_f32 v135, v46, v47
    s_add_u32 s72, s79, 0x310000
    buffer_store_dwordx4 v[132:135], v4, s[4:7], s72 offen sc1
    v_pk_fma_f32 v[16:17], v[88:89], s[34:35], v[120:121] op_sel:[0,0,0] op_sel_hi:[1,0,1] neg_lo:[0,1,0] neg_hi:[0,1,0]
    v_pk_fma_f32 v[18:19], v[90:91], s[34:35], v[122:123] op_sel:[0,0,0] op_sel_hi:[1,0,1] neg_lo:[0,1,0] neg_hi:[0,1,0]
    v_pk_fma_f32 v[20:21], v[92:93], s[34:35], v[124:125] op_sel:[0,0,0] op_sel_hi:[1,0,1] neg_lo:[0,1,0] neg_hi:[0,1,0]
    v_pk_fma_f32 v[22:23], v[94:95], s[34:35], v[126:127] op_sel:[0,0,0] op_sel_hi:[1,0,1] neg_lo:[0,1,0] neg_hi:[0,1,0]
    v_pk_fma_f32 v[24:25], v[72:73], s[34:35], v[104:105] op_sel:[0,0,0] op_sel_hi:[1,0,1] neg_lo:[0,1,0] neg_hi:[0,1,0]
    v_pk_fma_f32 v[26:27], v[74:75], s[34:35], v[106:107] op_sel:[0,0,0] op_sel_hi:[1,0,1] neg_lo:[0,1,0] neg_hi:[0,1,0]
    v_pk_fma_f32 v[28:29], v[76:77], s[34:35], v[108:109] op_sel:[0,0,0] op_sel_hi:[1,0,1] neg_lo:[0,1,0] neg_hi:[0,1,0]
    v_pk_fma_f32 v[30:31], v[78:79], s[34:35], v[110:111] op_sel:[0,0,0] op_sel_hi:[1,0,1] neg_lo:[0,1,0] neg_hi:[0,1,0]
    v_pk_fma_f32 v[32:33], v[24:25], s[32:33], v[16:17] op_sel:[0,1,0] op_sel_hi:[1,1,1]
    v_pk_fma_f32 v[34:35], v[26:27], s[32:33], v[18:19] op_sel:[0,1,0] op_sel_hi:[1,1,1]
    v_pk_fma_f32 v[36:37], v[28:29], s[32:33], v[20:21] op_sel:[0,1,0] op_sel_hi:[1,1,1]
    v_pk_fma_f32 v[38:39], v[30:31], s[32:33], v[22:23] op_sel:[0,1,0] op_sel_hi:[1,1,1]
    v_pk_fma_f32 v[40:41], v[24:25], s[32:33], v[16:17] op_sel:[0,1,0] op_sel_hi:[1,1,1] neg_lo:[0,1,0] neg_hi:[0,1,0]
    v_pk_fma_f32 v[42:43], v[26:27], s[32:33], v[18:19] op_sel:[0,1,0] op_sel_hi:[1,1,1] neg_lo:[0,1,0] neg_hi:[0,1,0]
    v_pk_fma_f32 v[44:45], v[28:29], s[32:33], v[20:21] op_sel:[0,1,0] op_sel_hi:[1,1,1] neg_lo:[0,1,0] neg_hi:[0,1,0]
    v_pk_fma_f32 v[46:47], v[30:31], s[32:33], v[22:23] op_sel:[0,1,0] op_sel_hi:[1,1,1] neg_lo:[0,1,0] neg_hi:[0,1,0]
    v_cvt_pk_bf16_f32 v136, v32, v33
    v_cvt_pk_bf16_f32 v137, v34, v35
    v_cvt_pk_bf16_f32 v138, v36, v37
    v_cvt_pk_bf16_f32 v139, v38, v39
    s_add_u32 s72, s79, 0x320000
    buffer_store_dwordx4 v[136:139], v4, s[4:7], s72 offen sc1
    v_cvt_pk_bf16_f32 v140, v40, v41
    v_cvt_pk_bf16_f32 v141, v42, v43
    v_cvt_pk_bf16_f32 v142, v44, v45
    v_cvt_pk_bf16_f32 v143, v46, v47
    s_add_u32 s72, s79, 0x330000
    buffer_store_dwordx4 v[140:143], v4, s[4:7], s72 offen sc1
    v_pk_fma_f32 v[16:17], v[88:89], s[36:37], v[120:121] op_sel:[0,1,0] op_sel_hi:[1,1,1] neg_lo:[0,1,0] neg_hi:[0,1,0]
    v_pk_fma_f32 v[18:19], v[90:91], s[36:37], v[122:123] op_sel:[0,1,0] op_sel_hi:[1,1,1] neg_lo:[0,1,0] neg_hi:[0,1,0]
    v_pk_fma_f32 v[20:21], v[92:93], s[36:37], v[124:125] op_sel:[0,1,0] op_sel_hi:[1,1,1] neg_lo:[0,1,0] neg_hi:[0,1,0]
    v_pk_fma_f32 v[22:23], v[94:95], s[36:37], v[126:127] op_sel:[0,1,0] op_sel_hi:[1,1,1] neg_lo:[0,1,0] neg_hi:[0,1,0]
    v_pk_mul_f32 v[24:25], v[72:73], s[36:37] op_sel:[0,0] op_sel_hi:[1,0]
    v_pk_mul_f32 v[26:27], v[74:75], s[36:37] op_sel:[0,0] op_sel_hi:[1,0]
    v_pk_mul_f32 v[28:29], v[76:77], s[36:37] op_sel:[0,0] op_sel_hi:[1,0]
    v_pk_mul_f32 v[30:31], v[78:79], s[36:37] op_sel:[0,0] op_sel_hi:[1,0]
    v_fmac_f32_dpp v16, v120, v55 row_shr:1 row_mask:0xf bank_mask:0xf bound_ctrl:0
    v_fmac_f32_dpp v17, v121, v55 row_shr:1 row_mask:0xf bank_mask:0xf bound_ctrl:0
    v_fmac_f32_dpp v18, v122, v55 row_shr:1 row_mask:0xf bank_mask:0xf bound_ctrl:0
    v_fmac_f32_dpp v19, v123, v55 row_shr:1 row_mask:0xf bank_mask:0xf bound_ctrl:0
    v_fmac_f32_dpp v20, v124, v55 row_shr:1 row_mask:0xf bank_mask:0xf bound_ctrl:0
    v_fmac_f32_dpp v21, v125, v55 row_shr:1 row_mask:0xf bank_mask:0xf bound_ctrl:0
    v_fmac_f32_dpp v22, v126, v55 row_shr:1 row_mask:0xf bank_mask:0xf bound_ctrl:0
    v_fmac_f32_dpp v23, v127, v55 row_shr:1 row_mask:0xf bank_mask:0xf bound_ctrl:0
    v_pk_fma_f32 v[24:25], v[104:105], s[36:37], v[24:25] op_sel:[0,1,0] op_sel_hi:[1,1,1] neg_lo:[0,1,0] neg_hi:[0,1,0]
    v_pk_fma_f32 v[26:27], v[106:107], s[36:37], v[26:27] op_sel:[0,1,0] op_sel_hi:[1,1,1] neg_lo:[0,1,0] neg_hi:[0,1,0]
    v_pk_fma_f32 v[28:29], v[108:109], s[36:37], v[28:29] op_sel:[0,1,0] op_sel_hi:[1,1,1] neg_lo:[0,1,0] neg_hi:[0,1,0]
    v_pk_fma_f32 v[30:31], v[110:111], s[36:37], v[30:31] op_sel:[0,1,0] op_sel_hi:[1,1,1] neg_lo:[0,1,0] neg_hi:[0,1,0]
    v_cvt_pk_bf16_f32 v144, v16, v17
    v_cvt_pk_bf16_f32 v145, v18, v19
    v_cvt_pk_bf16_f32 v146, v20, v21
    v_cvt_pk_bf16_f32 v147, v22, v23
    s_add_u32 s72, s79, 0x340000
    buffer_store_dwordx4 v[144:147], v4, s[4:7], s72 offen sc1
    v_add_f32_dpp v24, v72, v24 row_shl:1 row_mask:0xf bank_mask:0xf bound_ctrl:0
    v_add_f32_dpp v25, v73, v25 row_shl:1 row_mask:0xf bank_mask:0xf bound_ctrl:0
    v_add_f32_dpp v26, v74, v26 row_shl:1 row_mask:0xf bank_mask:0xf bound_ctrl:0
    v_add_f32_dpp v27, v75, v27 row_shl:1 row_mask:0xf bank_mask:0xf bound_ctrl:0
    v_add_f32_dpp v28, v76, v28 row_shl:1 row_mask:0xf bank_mask:0xf bound_ctrl:0
    v_add_f32_dpp v29, v77, v29 row_shl:1 row_mask:0xf bank_mask:0xf bound_ctrl:0
    v_add_f32_dpp v30, v78, v30 row_shl:1 row_mask:0xf bank_mask:0xf bound_ctrl:0
    v_add_f32_dpp v31, v79, v31 row_shl:1 row_mask:0xf bank_mask:0xf bound_ctrl:0
    v_cvt_pk_bf16_f32 v148, v24, v25
    v_cvt_pk_bf16_f32 v149, v26, v27
    v_cvt_pk_bf16_f32 v150, v28, v29
    v_cvt_pk_bf16_f32 v151, v30, v31
    s_add_u32 s72, s79, 0x350000
    buffer_store_dwordx4 v[148:151], v4, s[4:7], s72 offen sc1
    s_cmp_lg_u32 s3, 3
    s_cbranch_scc1 L_nopoll0
    buffer_load_dwordx2 v[64:65], v1, s[4:7], s86 offen sc1
L_nopoll0:
    s_mul_i32 s62, s58, 6291456
    s_lshl_b32 s72, s59, 10
    s_add_u32 s62, s62, s72
    s_add_u32 s62, s62, s66
    s_mul_i32 s65, s57, 589824
    s_add_u32 s65, s65, s66
    s_add_u32 s65, s65, 0xe00000
    s_lshr_b32 s72, s3, 1
    s_add_u32 s72, s72, 4
    s_and_b32 s73, s3, 1
    s_mul_i32 s73, s73, 6
    s_add_u32 s72, s72, s73
    s_mul_i32 s73, s72, 65536
    s_add_u32 s99, s62, s73
    s_mul_i32 s73, s72, 6144
    s_add_u32 s0, s65, s73
    s_mul_i32 s73, s3, 65536
    s_add_u32 s62, s62, s73
    s_mul_i32 s73, s3, 6144
    s_add_u32 s65, s65, s73
    s_sub_u32 s63, s62, 1024
    s_sub_u32 s100, s99, 1024
    s_cmp_eq_u32 s59, 0
    s_cselect_b32 s63, 0x80000000, s63
    s_cselect_b32 s100, 0x80000000, s100
    s_add_u32 s64, s62, 8192
    s_add_u32 s101, s99, 8192
    s_cmp_eq_u32 s59, 56
    s_cselect_b32 s64, 0x80000000, s64
    s_cselect_b32 s101, 0x80000000, s101
    v_mov_b32 v56, v50
    v_mov_b32 v57, v50
    s_cmp_lg_u32 s3, 1
    s_cbranch_scc1 L_nouhi
    s_add_u32 s70, s69, 0
    buffer_store_dwordx4 v[152:155], v2, s[4:7], s70 offen sc1
    s_add_u32 s70, s69, 6144
    buffer_store_dwordx4 v[156:159], v2, s[4:7], s70 offen sc1
    s_add_u32 s70, s69, 12288
    buffer_store_dwordx4 v[160:163], v2, s[4:7], s70 offen sc1
    s_add_u32 s70, s69, 18432
    buffer_store_dwordx4 v[164:167], v2, s[4:7], s70 offen sc1
    s_add_u32 s70, s69, 24576
    buffer_store_dwordx4 v[168:171], v2, s[4:7], s70 offen sc1
    s_add_u32 s70, s69, 30720
    buffer_store_dwordx4 v[172:175], v2, s[4:7], s70 offen sc1
    s_add_u32 s70, s69, 2048
    buffer_store_dwordx4 v[176:179], v2, s[4:7], s70 offen sc1
    s_add_u32 s70, s69, 8192
    buffer_store_dwordx4 v[180:183], v2, s[4:7], s70 offen sc1
    s_add_u32 s70, s69, 14336
    buffer_store_dwordx4 v[184:187], v2, s[4:7], s70 offen sc1
    s_add_u32 s70, s69, 20480
    buffer_store_dwordx4 v[188:191], v2, s[4:7], s70 offen sc1
    s_add_u32 s70, s69, 26624
    buffer_store_dwordx4 v[192:195], v2, s[4:7], s70 offen sc1
    s_add_u32 s70, s69, 32768
    buffer_store_dwordx4 v[196:199], v2, s[4:7], s70 offen sc1
    s_add_u32 s70, s69, 4096
    buffer_store_dwordx4 v[200:203], v2, s[4:7], s70 offen sc1
    s_add_u32 s70, s69, 10240
    buffer_store_dwordx4 v[204:207], v2, s[4:7], s70 offen sc1
    s_add_u32 s70, s69, 16384
    buffer_store_dwordx4 v[208:211], v2, s[4:7], s70 offen sc1
    s_add_u32 s70, s69, 22528
    buffer_store_dwordx4 v[212:215], v2, s[4:7], s70 offen sc1
    s_add_u32 s70, s69, 28672
    buffer_store_dwordx4 v[216:219], v2, s[4:7], s70 offen sc1
    s_add_u32 s70, s69, 34816
    buffer_store_dwordx4 v[220:223], v2, s[4:7], s70 offen sc1
    s_nop 1
L_nouhi:
    v_pk_mov_b32 v[128:129], 0, 0
    v_pk_mov_b32 v[130:131], 0, 0
    v_pk_mov_b32 v[132:133], 0, 0
    v_pk_mov_b32 v[134:135], 0, 0
    v_pk_mov_b32 v[136:137], 0, 0
    v_pk_mov_b32 v[138:139], 0, 0
    v_pk_mov_b32 v[140:141], 0, 0
    v_pk_mov_b32 v[142:143], 0, 0
    v_pk_mov_b32 v[144:145], 0, 0
    v_pk_mov_b32 v[146:147], 0, 0
    v_pk_mov_b32 v[148:149], 0, 0
    v_pk_mov_b32 v[150:151], 0, 0
    v_pk_mov_b32 v[152:153], 0, 0
    v_pk_mov_b32 v[154:155], 0, 0
    v_pk_mov_b32 v[156:157], 0, 0
    v_pk_mov_b32 v[158:159], 0, 0
    v_pk_mov_b32 v[160:161], 0, 0
    v_pk_mov_b32 v[162:163], 0, 0
    v_pk_mov_b32 v[164:165], 0, 0
    v_pk_mov_b32 v[166:167], 0, 0
    v_pk_mov_b32 v[168:169], 0, 0
    v_pk_mov_b32 v[170:171], 0, 0
    v_pk_mov_b32 v[172:173], 0, 0
    v_pk_mov_b32 v[174:175], 0, 0
    v_pk_mov_b32 v[176:177], 0, 0
    v_pk_mov_b32 v[178:179], 0, 0
    v_pk_mov_b32 v[180:181], 0, 0
    v_pk_mov_b32 v[182:183], 0, 0
    v_pk_mov_b32 v[184:185], 0, 0
    v_pk_mov_b32 v[186:187], 0, 0
    v_pk_mov_b32 v[188:189], 0, 0
    v_pk_mov_b32 v[190:191], 0, 0
    v_pk_mov_b32 v[192:193], 0, 0
    v_pk_mov_b32 v[194:195], 0, 0
    v_pk_mov_b32 v[196:197], 0, 0
    v_pk_mov_b32 v[198:199], 0, 0
    v_pk_mov_b32 v[200:201], 0, 0
    v_pk_mov_b32 v[202:203], 0, 0
    v_pk_mov_b32 v[204:205], 0, 0
    v_pk_mov_b32 v[206:207], 0, 0
    v_pk_mov_b32 v[208:209], 0, 0
    v_pk_mov_b32 v[210:211], 0, 0
    v_pk_mov_b32 v[212:213], 0, 0
    v_pk_mov_b32 v[214:215], 0, 0
    v_pk_mov_b32 v[216:217], 0, 0
    v_pk_mov_b32 v[218:219], 0, 0
    v_pk_mov_b32 v[220:221], 0, 0
    v_pk_mov_b32 v[222:223], 0, 0
    v_pk_mov_b32 v[224:225], 0, 0
    v_pk_mov_b32 v[226:227], 0, 0
    v_pk_mov_b32 v[228:229], 0, 0
    v_pk_mov_b32 v[230:231], 0, 0
    v_pk_mov_b32 v[232:233], 0, 0
    v_pk_mov_b32 v[234:235], 0, 0
    v_pk_mov_b32 v[236:237], 0, 0
    v_pk_mov_b32 v[238:239], 0, 0
    v_pk_mov_b32 v[240:241], 0, 0
    v_pk_mov_b32 v[242:243], 0, 0
    v_pk_mov_b32 v[244:245], 0, 0
    v_pk_mov_b32 v[246:247], 0, 0
    v_pk_mov_b32 v[248:249], 0, 0
    v_pk_mov_b32 v[250:251], 0, 0
    v_pk_mov_b32 v[252:253], 0, 0
    v_pk_mov_b32 v[254:255], 0, 0
    s_cmp_lg_u32 s3, 3
    s_cbranch_scc0 L_fpoll0
    v_add_u32 v8, 0, v0
    v_mul_u32_u24 v9, 1821, v8
    v_lshrrev_b32 v9, 16, v9
    v_mul_u32_u24 v10, 36, v9
    v_sub_u32 v8, v8, v10
    v_mul_u32_u24 v9, 9216, v9
    v_lshl_add_u32 v9, v8, 4, v9
    v_add_u32 v8, 46, v8
    v_lshrrev_b32 v8, 6, v8
    v_mul_u32_u24 v8, 288, v8
    v_add_u32 v64, v8, v9
    v_add_u32 v8, 64, v0
    v_mul_u32_u24 v9, 1821, v8
    v_lshrrev_b32 v9, 16, v9
    v_mul_u32_u24 v10, 36, v9
    v_sub_u32 v8, v8, v10
    v_mul_u32_u24 v9, 9216, v9
    v_lshl_add_u32 v9, v8, 4, v9
    v_add_u32 v8, 46, v8
    v_lshrrev_b32 v8, 6, v8
    v_mul_u32_u24 v8, 288, v8
    v_add_u32 v65, v8, v9
    v_add_u32 v8, 128, v0
    v_mul_u32_u24 v9, 1821, v8
    v_lshrrev_b32 v9, 16, v9
    v_mul_u32_u24 v10, 36, v9
    v_sub_u32 v8, v8, v10
    v_mul_u32_u24 v9, 9216, v9
    v_lshl_add_u32 v9, v8, 4, v9
    v_add_u32 v8, 46, v8
    v_lshrrev_b32 v8, 6, v8
    v_mul_u32_u24 v8, 288, v8
    v_add_u32 v66, v8, v9
    v_add_u32 v8, 192, v0
    v_mul_u32_u24 v9, 1821, v8
    v_lshrrev_b32 v9, 16, v9
    v_mul_u32_u24 v10, 36, v9
    v_sub_u32 v8, v8, v10
    v_mul_u32_u24 v9, 9216, v9
    v_lshl_add_u32 v9, v8, 4, v9
    v_add_u32 v8, 46, v8
    v_lshrrev_b32 v8, 6, v8
    v_mul_u32_u24 v8, 288, v8
    v_add_u32 v67, v8, v9
    v_add_u32 v8, 256, v0
    v_mul_u32_u24 v9, 1821, v8
    v_lshrrev_b32 v9, 16, v9
    v_mul_u32_u24 v10, 36, v9
    v_sub_u32 v8, v8, v10
    v_mul_u32_u24 v9, 9216, v9
    v_lshl_add_u32 v9, v8, 4, v9
    v_add_u32 v8, 46, v8
    v_lshrrev_b32 v8, 6, v8
    v_mul_u32_u24 v8, 288, v8
    v_add_u32 v68, v8, v9
    v_add_u32 v8, 320, v0
    v_mul_u32_u24 v9, 1821, v8
    v_lshrrev_b32 v9, 16, v9
    v_mul_u32_u24 v10, 36, v9
    v_sub_u32 v8, v8, v10
    v_mul_u32_u24 v9, 9216, v9
    v_lshl_add_u32 v9, v8, 4, v9
    v_add_u32 v8, 46, v8
    v_lshrrev_b32 v8, 6, v8
    v_mul_u32_u24 v8, 288, v8
    v_add_u32 v69, v8, v9
    v_add_u32 v8, 384, v0
    v_mul_u32_u24 v9, 1821, v8
    v_lshrrev_b32 v9, 16, v9
    v_mul_u32_u24 v10, 36, v9
    v_sub_u32 v8, v8, v10
    v_mul_u32_u24 v9, 9216, v9
    v_lshl_add_u32 v9, v8, 4, v9
    v_add_u32 v8, 46, v8
    v_lshrrev_b32 v8, 6, v8
    v_mul_u32_u24 v8, 288, v8
    v_add_u32 v70, v8, v9
    v_add_u32 v8, 448, v0
    v_mul_u32_u24 v9, 1821, v8
    v_lshrrev_b32 v9, 16, v9
    v_mul_u32_u24 v10, 36, v9
    v_sub_u32 v8, v8, v10
    v_mul_u32_u24 v9, 9216, v9
    v_lshl_add_u32 v9, v8, 4, v9
    v_add_u32 v8, 46, v8
    v_lshrrev_b32 v8, 6, v8
    v_mul_u32_u24 v8, 288, v8
    v_add_u32 v71, v8, v9
    v_add_u32 v8, 512, v0
    v_mul_u32_u24 v9, 1821, v8
    v_lshrrev_b32 v9, 16, v9
    v_mul_u32_u24 v10, 36, v9
    v_sub_u32 v8, v8, v10
    v_mul_u32_u24 v9, 9216, v9
    v_lshl_add_u32 v9, v8, 4, v9
    v_add_u32 v8, 46, v8
    v_lshrrev_b32 v8, 6, v8
    v_mul_u32_u24 v8, 288, v8
    v_add_u32 v72, v8, v9
    s_cmp_eq_u32 s3, 1
    s_cbranch_scc1 L_fready
    s_waitcnt vmcnt(0)
    s_branch L_fready
L_fpoll0:
    s_mov_b32 s71, 100000
L_fpoll:
    s_waitcnt vmcnt(0)
L_fpoll1:
    v_cmp_ne_u32 vcc, s61, v64
    v_cmp_ne_u32 s[80:81], s61, v65
    s_nop 1
    s_or_b64 s[80:81], s[80:81], vcc
    s_cbranch_scc0 L_fready
    s_sleep 1
    buffer_load_dwordx2 v[64:65], v1, s[4:7], s86 offen sc1
    s_sub_u32 s71, s71, 1
    s_cmp_lg_u32 s71, 0
    s_cbranch_scc1 L_fpoll
L_fready:
    s_barrier
    buffer_load_dwordx4 a[0:3], v2, s[4:7], s0 offen offset:0 sc1
    buffer_load_dwordx4 a[24:27], v2, s[4:7], s100 offen sc1
    buffer_load_dwordx4 a[28:31], v2, s[4:7], s99 offen offset:0 sc1
    buffer_load_dwordx4 a[4:7], v2, s[4:7], s0 offen offset:1024 sc1
    buffer_load_dwordx4 a[8:11], v2, s[4:7], s0 offen offset:2048 sc1
    buffer_load_dwordx4 a[32:35], v2, s[4:7], s99 offen offset:1024 sc1
    buffer_load_dwordx4 a[12:15], v2, s[4:7], s0 offen offset:3072 sc1
    buffer_load_dwordx4 a[16:19], v3, s[4:7], s0 offen offset:0 sc1
    buffer_load_dwordx4 a[36:39], v2, s[4:7], s99 offen offset:2048 sc1
    buffer_load_dwordx4 a[20:23], v3, s[4:7], s0 offen offset:1024 sc1
    buffer_load_dwordx4 a[40:43], v2, s[4:7], s99 offen offset:3072 sc1
    buffer_load_dwordx4 a[44:47], v3, s[4:7], s99 offen offset:0 sc1
    buffer_load_dwordx4 a[48:51], v3, s[4:7], s99 offen offset:1024 sc1
    buffer_load_dwordx4 a[52:55], v3, s[4:7], s99 offen offset:2048 sc1
    buffer_load_dwordx4 a[56:59], v3, s[4:7], s99 offen offset:3072 sc1
    buffer_load_dwordx4 a[60:63], v2, s[4:7], s101 offen sc1
    s_add_u32 s99, s99, 0xc0000
    s_add_u32 s100, s100, 0xc0000
    s_add_u32 s101, s101, 0xc0000
    s_add_u32 s0, s0, 73728
    s_lshl_b32 s72, s60, 2
    s_add_u32 s72, s72, s3
    s_cmp_eq_u32 s72, 1
    s_cselect_b32 s94, 1, 0
    s_cbranch_scc0 L_noemb
    s_lshl_b32 s72, s57, 12
    s_lshl_b32 s73, s58, 7
    s_add_u32 s72, s72, s73
    s_add_u32 s72, s72, 0x1710000
    v_lshrrev_b32 v9, 4, v0
    v_lshlrev_b32 v9, 5, v9
    v_lshl_add_u32 v8, v6, 8, v9
    buffer_load_dwordx4 v[88:91], v8, s[4:7], s72 offen sc1
    buffer_load_dwordx4 v[92:95], v8, s[4:7], s72 offen offset:16 sc1
    v_add_u32 v96, 131200, v9
L_noemb:
    s_add_u32 s75, s86, 65536
L_nof1:
    s_mov_b32 s71, 7
.p2align 3
L_loop:
    s_waitcnt vmcnt(6)
    s_cmp_eq_u32 s71, 6
    s_cbranch_scc1 L_fl1_st
L_fl1st_back:
    v_mfma_f32_16x16x32_bf16 v[192:195], a[0:3], a[24:27], v[192:195]
    buffer_load_dwordx4 a[64:67], v2, s[4:7], s65 offen offset:0 sc1
    v_mfma_f32_16x16x32_bf16 v[200:203], a[0:3], a[28:31], v[200:203]
    buffer_load_dwordx4 a[88:91], v2, s[4:7], s63 offen sc1
    v_mfma_f32_16x16x32_bf16 v[196:199], a[4:7], a[24:27], v[196:199]
    buffer_load_dwordx4 a[92:95], v2, s[4:7], s62 offen offset:0 sc1
    v_mfma_f32_16x16x32_bf16 v[204:207], a[4:7], a[28:31], v[204:207]
    buffer_load_dwordx4 a[68:71], v2, s[4:7], s65 offen offset:1024 sc1
    v_mfma_f32_16x16x32_bf16 v[192:195], a[8:11], a[28:31], v[192:195]
    buffer_load_dwordx4 a[72:75], v2, s[4:7], s65 offen offset:2048 sc1
    v_mfma_f32_16x16x32_bf16 v[200:203], a[8:11], a[32:35], v[200:203]
    buffer_load_dwordx4 a[96:99], v2, s[4:7], s62 offen offset:1024 sc1
    v_mfma_f32_16x16x32_bf16 v[196:199], a[12:15], a[28:31], v[196:199]
    buffer_load_dwordx4 a[76:79], v2, s[4:7], s65 offen offset:3072 sc1
    v_mfma_f32_16x16x32_bf16 v[204:207], a[12:15], a[32:35], v[204:207]
    buffer_load_dwordx4 a[80:83], v3, s[4:7], s65 offen offset:0 sc1
    v_mfma_f32_16x16x32_bf16 v[192:195], a[16:19], a[32:35], v[192:195]
    buffer_load_dwordx4 a[100:103], v2, s[4:7], s62 offen offset:2048 sc1
    v_mfma_f32_16x16x32_bf16 v[200:203], a[16:19], a[36:39], v[200:203]
    buffer_load_dwordx4 a[84:87], v3, s[4:7], s65 offen offset:1024 sc1
    v_mfma_f32_16x16x32_bf16 v[196:199], a[20:23], a[32:35], v[196:199]
    buffer_load_dwordx4 a[104:107], v2, s[4:7], s62 offen offset:3072 sc1
    v_mfma_f32_16x16x32_bf16 v[204:207], a[20:23], a[36:39], v[204:207]
    buffer_load_dwordx4 a[108:111], v3, s[4:7], s62 offen offset:0 sc1
    s_waitcnt vmcnt(16)
    v_mfma_f32_16x16x32_bf16 v[208:211], a[0:3], a[32:35], v[208:211]
    buffer_load_dwordx4 a[112:115], v3, s[4:7], s62 offen offset:1024 sc1
    v_mfma_f32_16x16x32_bf16 v[216:219], a[0:3], a[36:39], v[216:219]
    buffer_load_dwordx4 a[116:119], v3, s[4:7], s62 offen offset:2048 sc1
    v_mfma_f32_16x16x32_bf16 v[212:215], a[4:7], a[32:35], v[212:215]
    buffer_load_dwordx4 a[120:123], v3, s[4:7], s62 offen offset:3072 sc1
    v_mfma_f32_16x16x32_bf16 v[220:223], a[4:7], a[36:39], v[220:223]
    buffer_load_dwordx4 a[124:127], v2, s[4:7], s64 offen sc1
    v_mfma_f32_16x16x32_bf16 v[208:211], a[8:11], a[36:39], v[208:211]
    v_mfma_f32_16x16x32_bf16 v[216:219], a[8:11], a[40:43], v[216:219]
    v_mfma_f32_16x16x32_bf16 v[212:215], a[12:15], a[36:39], v[212:215]
    v_mfma_f32_16x16x32_bf16 v[220:223], a[12:15], a[40:43], v[220:223]
    v_mfma_f32_16x16x32_bf16 v[208:211], a[16:19], a[40:43], v[208:211]
    v_mfma_f32_16x16x32_bf16 v[216:219], a[16:19], a[44:47], v[216:219]
    v_mfma_f32_16x16x32_bf16 v[212:215], a[20:23], a[40:43], v[212:215]
    v_mfma_f32_16x16x32_bf16 v[220:223], a[20:23], a[44:47], v[220:223]
    s_waitcnt vmcnt(18)
    v_mfma_f32_16x16x32_bf16 v[224:227], a[0:3], a[40:43], v[224:227]
    v_mfma_f32_16x16x32_bf16 v[232:235], a[0:3], a[44:47], v[232:235]
    v_mfma_f32_16x16x32_bf16 v[228:231], a[4:7], a[40:43], v[228:231]
    v_mfma_f32_16x16x32_bf16 v[236:239], a[4:7], a[44:47], v[236:239]
    v_mfma_f32_16x16x32_bf16 v[224:227], a[8:11], a[44:47], v[224:227]
    v_mfma_f32_16x16x32_bf16 v[232:235], a[8:11], a[48:51], v[232:235]
    v_mfma_f32_16x16x32_bf16 v[228:231], a[12:15], a[44:47], v[228:231]
    v_mfma_f32_16x16x32_bf16 v[236:239], a[12:15], a[48:51], v[236:239]
    v_mfma_f32_16x16x32_bf16 v[224:227], a[16:19], a[48:51], v[224:227]
    v_mfma_f32_16x16x32_bf16 v[232:235], a[16:19], a[52:55], v[232:235]
    v_mfma_f32_16x16x32_bf16 v[228:231], a[20:23], a[48:51], v[228:231]
    v_mfma_f32_16x16x32_bf16 v[236:239], a[20:23], a[52:55], v[236:239]
    s_waitcnt vmcnt(16)
    v_mfma_f32_16x16x32_bf16 v[240:243], a[0:3], a[48:51], v[240:243]
    v_mfma_f32_16x16x32_bf16 v[248:251], a[0:3], a[52:55], v[248:251]
    v_mfma_f32_16x16x32_bf16 v[244:247], a[4:7], a[48:51], v[244:247]
    v_mfma_f32_16x16x32_bf16 v[252:255], a[4:7], a[52:55], v[252:255]
    v_mfma_f32_16x16x32_bf16 v[240:243], a[8:11], a[52:55], v[240:243]
    v_mfma_f32_16x16x32_bf16 v[248:251], a[8:11], a[56:59], v[248:251]
    v_mfma_f32_16x16x32_bf16 v[244:247], a[12:15], a[52:55], v[244:247]
    v_mfma_f32_16x16x32_bf16 v[252:255], a[12:15], a[56:59], v[252:255]
    v_mfma_f32_16x16x32_bf16 v[240:243], a[16:19], a[56:59], v[240:243]
    v_mfma_f32_16x16x32_bf16 v[248:251], a[16:19], a[60:63], v[248:251]
    v_mfma_f32_16x16x32_bf16 v[244:247], a[20:23], a[56:59], v[244:247]
    v_mfma_f32_16x16x32_bf16 v[252:255], a[20:23], a[60:63], v[252:255]
    s_add_u32 s62, s62, 0x60000
    s_add_u32 s63, s63, 0x60000
    s_add_u32 s64, s64, 0x60000
    s_add_u32 s65, s65, 36864
    s_waitcnt vmcnt(6)
    s_cmp_eq_u32 s71, 4
    s_cbranch_scc1 L_fl1_ld
    s_cmp_eq_u32 s71, 2
    s_cbranch_scc1 L_pre
L_fl1_back:
    v_mfma_f32_16x16x32_bf16 v[128:131], a[64:67], a[88:91], v[128:131]
    buffer_load_dwordx4 a[128:131], v2, s[4:7], s65 offen offset:0 sc1
    v_mfma_f32_16x16x32_bf16 v[136:139], a[64:67], a[92:95], v[136:139]
    buffer_load_dwordx4 a[152:155], v2, s[4:7], s63 offen sc1
    v_mfma_f32_16x16x32_bf16 v[132:135], a[68:71], a[88:91], v[132:135]
    buffer_load_dwordx4 a[156:159], v2, s[4:7], s62 offen offset:0 sc1
    v_mfma_f32_16x16x32_bf16 v[140:143], a[68:71], a[92:95], v[140:143]
    buffer_load_dwordx4 a[132:135], v2, s[4:7], s65 offen offset:1024 sc1
    v_mfma_f32_16x16x32_bf16 v[128:131], a[72:75], a[92:95], v[128:131]
    buffer_load_dwordx4 a[136:139], v2, s[4:7], s65 offen offset:2048 sc1
    v_mfma_f32_16x16x32_bf16 v[136:139], a[72:75], a[96:99], v[136:139]
    buffer_load_dwordx4 a[160:163], v2, s[4:7], s62 offen offset:1024 sc1
    v_mfma_f32_16x16x32_bf16 v[132:135], a[76:79], a[92:95], v[132:135]
    buffer_load_dwordx4 a[140:143], v2, s[4:7], s65 offen offset:3072 sc1
    v_mfma_f32_16x16x32_bf16 v[140:143], a[76:79], a[96:99], v[140:143]
    buffer_load_dwordx4 a[144:147], v3, s[4:7], s65 offen offset:0 sc1
    v_mfma_f32_16x16x32_bf16 v[128:131], a[80:83], a[96:99], v[128:131]
    buffer_load_dwordx4 a[164:167], v2, s[4:7], s62 offen offset:2048 sc1
    v_mfma_f32_16x16x32_bf16 v[136:139], a[80:83], a[100:103], v[136:139]
    buffer_load_dwordx4 a[148:151], v3, s[4:7], s65 offen offset:1024 sc1
    v_mfma_f32_16x16x32_bf16 v[132:135], a[84:87], a[96:99], v[132:135]
    buffer_load_dwordx4 a[168:171], v2, s[4:7], s62 offen offset:3072 sc1
    v_mfma_f32_16x16x32_bf16 v[140:143], a[84:87], a[100:103], v[140:143]
    buffer_load_dwordx4 a[172:175], v3, s[4:7], s62 offen offset:0 sc1
    s_waitcnt vmcnt(16)
    v_mfma_f32_16x16x32_bf16 v[144:147], a[64:67], a[96:99], v[144:147]
    buffer_load_dwordx4 a[176:179], v3, s[4:7], s62 offen offset:1024 sc1
    v_mfma_f32_16x16x32_bf16 v[152:155], a[64:67], a[100:103], v[152:155]
    buffer_load_dwordx4 a[180:183], v3, s[4:7], s62 offen offset:2048 sc1
    v_mfma_f32_16x16x32_bf16 v[148:151], a[68:71], a[96:99], v[148:151]
    buffer_load_dwordx4 a[184:187], v3, s[4:7], s62 offen offset:3072 sc1
    v_mfma_f32_16x16x32_bf16 v[156:159], a[68:71], a[100:103], v[156:159]
    buffer_load_dwordx4 a[188:191], v2, s[4:7], s64 offen sc1
    v_mfma_f32_16x16x32_bf16 v[144:147], a[72:75], a[100:103], v[144:147]
    v_mfma_f32_16x16x32_bf16 v[152:155], a[72:75], a[104:107], v[152:155]
    v_mfma_f32_16x16x32_bf16 v[148:151], a[76:79], a[100:103], v[148:151]
    v_mfma_f32_16x16x32_bf16 v[156:159], a[76:79], a[104:107], v[156:159]
    v_mfma_f32_16x16x32_bf16 v[144:147], a[80:83], a[104:107], v[144:147]
    v_mfma_f32_16x16x32_bf16 v[152:155], a[80:83], a[108:111], v[152:155]
    v_mfma_f32_16x16x32_bf16 v[148:151], a[84:87], a[104:107], v[148:151]
    v_mfma_f32_16x16x32_bf16 v[156:159], a[84:87], a[108:111], v[156:159]
    s_waitcnt vmcnt(18)
    v_mfma_f32_16x16x32_bf16 v[160:163], a[64:67], a[104:107], v[160:163]
    v_mfma_f32_16x16x32_bf16 v[168:171], a[64:67], a[108:111], v[168:171]
    v_mfma_f32_16x16x32_bf16 v[164:167], a[68:71], a[104:107], v[164:167]
    v_mfma_f32_16x16x32_bf16 v[172:175], a[68:71], a[108:111], v[172:175]
    v_mfma_f32_16x16x32_bf16 v[160:163], a[72:75], a[108:111], v[160:163]
    v_mfma_f32_16x16x32_bf16 v[168:171], a[72:75], a[112:115], v[168:171]
    v_mfma_f32_16x16x32_bf16 v[164:167], a[76:79], a[108:111], v[164:167]
    v_mfma_f32_16x16x32_bf16 v[172:175], a[76:79], a[112:115], v[172:175]
    v_mfma_f32_16x16x32_bf16 v[160:163], a[80:83], a[112:115], v[160:163]
    v_mfma_f32_16x16x32_bf16 v[168:171], a[80:83], a[116:119], v[168:171]
    v_mfma_f32_16x16x32_bf16 v[164:167], a[84:87], a[112:115], v[164:167]
    v_mfma_f32_16x16x32_bf16 v[172:175], a[84:87], a[116:119], v[172:175]
    s_waitcnt vmcnt(16)
    v_mfma_f32_16x16x32_bf16 v[176:179], a[64:67], a[112:115], v[176:179]
    v_mfma_f32_16x16x32_bf16 v[184:187], a[64:67], a[116:119], v[184:187]
    v_mfma_f32_16x16x32_bf16 v[180:183], a[68:71], a[112:115], v[180:183]
    v_mfma_f32_16x16x32_bf16 v[188:191], a[68:71], a[116:119], v[188:191]
    v_mfma_f32_16x16x32_bf16 v[176:179], a[72:75], a[116:119], v[176:179]
    v_mfma_f32_16x16x32_bf16 v[184:187], a[72:75], a[120:123], v[184:187]
    v_mfma_f32_16x16x32_bf16 v[180:183], a[76:79], a[116:119], v[180:183]
    v_mfma_f32_16x16x32_bf16 v[188:191], a[76:79], a[120:123], v[188:191]
    v_mfma_f32_16x16x32_bf16 v[176:179], a[80:83], a[120:123], v[176:179]
    v_mfma_f32_16x16x32_bf16 v[184:187], a[80:83], a[124:127], v[184:187]
    v_mfma_f32_16x16x32_bf16 v[180:183], a[84:87], a[120:123], v[180:183]
    v_mfma_f32_16x16x32_bf16 v[188:191], a[84:87], a[124:127], v[188:191]
    s_add_u32 s62, s62, 0x60000
    s_add_u32 s63, s63, 0x60000
    s_add_u32 s64, s64, 0x60000
    s_add_u32 s65, s65, 36864
    s_waitcnt vmcnt(6)
    s_cmp_eq_u32 s71, 4
    s_cbranch_scc1 L_chk
L_chk_back:
    v_mfma_f32_16x16x32_bf16 v[128:131], a[128:131], a[152:155], v[128:131]
    buffer_load_dwordx4 a[0:3], v2, s[4:7], s0 offen offset:0 sc1
    v_mfma_f32_16x16x32_bf16 v[136:139], a[128:131], a[156:159], v[136:139]
    buffer_load_dwordx4 a[24:27], v2, s[4:7], s100 offen sc1
    v_mfma_f32_16x16x32_bf16 v[132:135], a[132:135], a[152:155], v[132:135]
    buffer_load_dwordx4 a[28:31], v2, s[4:7], s99 offen offset:0 sc1
    v_mfma_f32_16x16x32_bf16 v[140:143], a[132:135], a[156:159], v[140:143]
    buffer_load_dwordx4 a[4:7], v2, s[4:7], s0 offen offset:1024 sc1
    v_mfma_f32_16x16x32_bf16 v[128:131], a[136:139], a[156:159], v[128:131]
    buffer_load_dwordx4 a[8:11], v2, s[4:7], s0 offen offset:2048 sc1
    v_mfma_f32_16x16x32_bf16 v[136:139], a[136:139], a[160:163], v[136:139]
    buffer_load_dwordx4 a[32:35], v2, s[4:7], s99 offen offset:1024 sc1
    v_mfma_f32_16x16x32_bf16 v[132:135], a[140:143], a[156:159], v[132:135]
    buffer_load_dwordx4 a[12:15], v2, s[4:7], s0 offen offset:3072 sc1
    v_mfma_f32_16x16x32_bf16 v[140:143], a[140:143], a[160:163], v[140:143]
    buffer_load_dwordx4 a[16:19], v3, s[4:7], s0 offen offset:0 sc1
    v_mfma_f32_16x16x32_bf16 v[128:131], a[144:147], a[160:163], v[128:131]
    buffer_load_dwordx4 a[36:39], v2, s[4:7], s99 offen offset:2048 sc1
    v_mfma_f32_16x16x32_bf16 v[136:139], a[144:147], a[164:167], v[136:139]
    buffer_load_dwordx4 a[20:23], v3, s[4:7], s0 offen offset:1024 sc1
    v_mfma_f32_16x16x32_bf16 v[132:135], a[148:151], a[160:163], v[132:135]
    buffer_load_dwordx4 a[40:43], v2, s[4:7], s99 offen offset:3072 sc1
    v_mfma_f32_16x16x32_bf16 v[140:143], a[148:151], a[164:167], v[140:143]
    buffer_load_dwordx4 a[44:47], v3, s[4:7], s99 offen offset:0 sc1
    s_waitcnt vmcnt(16)
    v_mfma_f32_16x16x32_bf16 v[144:147], a[128:131], a[160:163], v[144:147]
    buffer_load_dwordx4 a[48:51], v3, s[4:7], s99 offen offset:1024 sc1
    v_mfma_f32_16x16x32_bf16 v[152:155], a[128:131], a[164:167], v[152:155]
    buffer_load_dwordx4 a[52:55], v3, s[4:7], s99 offen offset:2048 sc1
    v_mfma_f32_16x16x32_bf16 v[148:151], a[132:135], a[160:163], v[148:151]
    buffer_load_dwordx4 a[56:59], v3, s[4:7], s99 offen offset:3072 sc1
    v_mfma_f32_16x16x32_bf16 v[156:159], a[132:135], a[164:167], v[156:159]
    buffer_load_dwordx4 a[60:63], v2, s[4:7], s101 offen sc1
    v_mfma_f32_16x16x32_bf16 v[144:147], a[136:139], a[164:167], v[144:147]
    v_mfma_f32_16x16x32_bf16 v[152:155], a[136:139], a[168:171], v[152:155]
    v_mfma_f32_16x16x32_bf16 v[148:151], a[140:143], a[164:167], v[148:151]
    v_mfma_f32_16x16x32_bf16 v[156:159], a[140:143], a[168:171], v[156:159]
    v_mfma_f32_16x16x32_bf16 v[144:147], a[144:147], a[168:171], v[144:147]
    v_mfma_f32_16x16x32_bf16 v[152:155], a[144:147], a[172:175], v[152:155]
    v_mfma_f32_16x16x32_bf16 v[148:151], a[148:151], a[168:171], v[148:151]
    v_mfma_f32_16x16x32_bf16 v[156:159], a[148:151], a[172:175], v[156:159]
    s_waitcnt vmcnt(18)
    v_mfma_f32_16x16x32_bf16 v[160:163], a[128:131], a[168:171], v[160:163]
    v_mfma_f32_16x16x32_bf16 v[168:171], a[128:131], a[172:175], v[168:171]
    v_mfma_f32_16x16x32_bf16 v[164:167], a[132:135], a[168:171], v[164:167]
    v_mfma_f32_16x16x32_bf16 v[172:175], a[132:135], a[172:175], v[172:175]
    v_mfma_f32_16x16x32_bf16 v[160:163], a[136:139], a[172:175], v[160:163]
    v_mfma_f32_16x16x32_bf16 v[168:171], a[136:139], a[176:179], v[168:171]
    v_mfma_f32_16x16x32_bf16 v[164:167], a[140:143], a[172:175], v[164:167]
    v_mfma_f32_16x16x32_bf16 v[172:175], a[140:143], a[176:179], v[172:175]
    v_mfma_f32_16x16x32_bf16 v[160:163], a[144:147], a[176:179], v[160:163]
    v_mfma_f32_16x16x32_bf16 v[168:171], a[144:147], a[180:183], v[168:171]
    v_mfma_f32_16x16x32_bf16 v[164:167], a[148:151], a[176:179], v[164:167]
    v_mfma_f32_16x16x32_bf16 v[172:175], a[148:151], a[180:183], v[172:175]
    s_waitcnt vmcnt(16)
    v_mfma_f32_16x16x32_bf16 v[176:179], a[128:131], a[176:179], v[176:179]
    v_mfma_f32_16x16x32_bf16 v[184:187], a[128:131], a[180:183], v[184:187]
    v_mfma_f32_16x16x32_bf16 v[180:183], a[132:135], a[176:179], v[180:183]
    v_mfma_f32_16x16x32_bf16 v[188:191], a[132:135], a[180:183], v[188:191]
    v_mfma_f32_16x16x32_bf16 v[176:179], a[136:139], a[180:183], v[176:179]
    v_mfma_f32_16x16x32_bf16 v[184:187], a[136:139], a[184:187], v[184:187]
    v_mfma_f32_16x16x32_bf16 v[180:183], a[140:143], a[180:183], v[180:183]
    v_mfma_f32_16x16x32_bf16 v[188:191], a[140:143], a[184:187], v[188:191]
    v_mfma_f32_16x16x32_bf16 v[176:179], a[144:147], a[184:187], v[176:179]
    v_mfma_f32_16x16x32_bf16 v[184:187], a[144:147], a[188:191], v[184:187]
    v_mfma_f32_16x16x32_bf16 v[180:183], a[148:151], a[184:187], v[180:183]
    v_mfma_f32_16x16x32_bf16 v[188:191], a[148:151], a[188:191], v[188:191]
    s_add_u32 s99, s99, 0xc0000
    s_add_u32 s100, s100, 0xc0000
    s_add_u32 s101, s101, 0xc0000
    s_add_u32 s0, s0, 73728
    s_sub_u32 s71, s71, 1
    s_cmp_lg_u32 s71, 0
    s_cbranch_scc1 L_loop
    s_waitcnt vmcnt(6)
    v_mfma_f32_16x16x32_bf16 v[192:195], a[0:3], a[24:27], v[192:195]
    buffer_load_dwordx4 a[64:67], v2, s[4:7], s65 offen offset:0 sc1
    v_mfma_f32_16x16x32_bf16 v[200:203], a[0:3], a[28:31], v[200:203]
    buffer_load_dwordx4 a[88:91], v2, s[4:7], s63 offen sc1
    v_mfma_f32_16x16x32_bf16 v[196:199], a[4:7], a[24:27], v[196:199]
    buffer_load_dwordx4 a[92:95], v2, s[4:7], s62 offen offset:0 sc1
    v_mfma_f32_16x16x32_bf16 v[204:207], a[4:7], a[28:31], v[204:207]
    buffer_load_dwordx4 a[68:71], v2, s[4:7], s65 offen offset:1024 sc1
    v_mfma_f32_16x16x32_bf16 v[192:195], a[8:11], a[28:31], v[192:195]
    buffer_load_dwordx4 a[72:75], v2, s[4:7], s65 offen offset:2048 sc1
    v_mfma_f32_16x16x32_bf16 v[200:203], a[8:11], a[32:35], v[200:203]
    buffer_load_dwordx4 a[96:99], v2, s[4:7], s62 offen offset:1024 sc1
    v_mfma_f32_16x16x32_bf16 v[196:199], a[12:15], a[28:31], v[196:199]
    buffer_load_dwordx4 a[76:79], v2, s[4:7], s65 offen offset:3072 sc1
    v_mfma_f32_16x16x32_bf16 v[204:207], a[12:15], a[32:35], v[204:207]
    buffer_load_dwordx4 a[80:83], v3, s[4:7], s65 offen offset:0 sc1
    v_mfma_f32_16x16x32_bf16 v[192:195], a[16:19], a[32:35], v[192:195]
    buffer_load_dwordx4 a[100:103], v2, s[4:7], s62 offen offset:2048 sc1
    v_mfma_f32_16x16x32_bf16 v[200:203], a[16:19], a[36:39], v[200:203]
    buffer_load_dwordx4 a[84:87], v3, s[4:7], s65 offen offset:1024 sc1
    v_mfma_f32_16x16x32_bf16 v[196:199], a[20:23], a[32:35], v[196:199]
    buffer_load_dwordx4 a[104:107], v2, s[4:7], s62 offen offset:3072 sc1
    v_mfma_f32_16x16x32_bf16 v[204:207], a[20:23], a[36:39], v[204:207]
    buffer_load_dwordx4 a[108:111], v3, s[4:7], s62 offen offset:0 sc1
    s_waitcnt vmcnt(16)
    v_mfma_f32_16x16x32_bf16 v[208:211], a[0:3], a[32:35], v[208:211]
    buffer_load_dwordx4 a[112:115], v3, s[4:7], s62 offen offset:1024 sc1
    v_mfma_f32_16x16x32_bf16 v[216:219], a[0:3], a[36:39], v[216:219]
    buffer_load_dwordx4 a[116:119], v3, s[4:7], s62 offen offset:2048 sc1
    v_mfma_f32_16x16x32_bf16 v[212:215], a[4:7], a[32:35], v[212:215]
    buffer_load_dwordx4 a[120:123], v3, s[4:7], s62 offen offset:3072 sc1
    v_mfma_f32_16x16x32_bf16 v[220:223], a[4:7], a[36:39], v[220:223]
    buffer_load_dwordx4 a[124:127], v2, s[4:7], s64 offen sc1
    v_mfma_f32_16x16x32_bf16 v[208:211], a[8:11], a[36:39], v[208:211]
    v_mfma_f32_16x16x32_bf16 v[216:219], a[8:11], a[40:43], v[216:219]
    v_mfma_f32_16x16x32_bf16 v[212:215], a[12:15], a[36:39], v[212:215]
    ds_write_b128 v8, v[192:195] offset:4096
    v_mfma_f32_16x16x32_bf16 v[220:223], a[12:15], a[40:43], v[220:223]
    ds_write_b128 v8, v[200:203] offset:6144
    v_mfma_f32_16x16x32_bf16 v[208:211], a[16:19], a[40:43], v[208:211]
    ds_write_b128 v8, v[196:199] offset:5120
    v_mfma_f32_16x16x32_bf16 v[216:219], a[16:19], a[44:47], v[216:219]
    ds_write_b128 v8, v[204:207] offset:7168
    v_mfma_f32_16x16x32_bf16 v[212:215], a[20:23], a[40:43], v[212:215]
    v_mfma_f32_16x16x32_bf16 v[220:223], a[20:23], a[44:47], v[220:223]
    s_waitcnt vmcnt(18)
    v_mfma_f32_16x16x32_bf16 v[224:227], a[0:3], a[40:43], v[224:227]
    v_mfma_f32_16x16x32_bf16 v[232:235], a[0:3], a[44:47], v[232:235]
    v_mfma_f32_16x16x32_bf16 v[228:231], a[4:7], a[40:43], v[228:231]
    v_mfma_f32_16x16x32_bf16 v[236:239], a[4:7], a[44:47], v[236:239]
    v_mfma_f32_16x16x32_bf16 v[224:227], a[8:11], a[44:47], v[224:227]
    v_mfma_f32_16x16x32_bf16 v[232:235], a[8:11], a[48:51], v[232:235]
    v_mfma_f32_16x16x32_bf16 v[228:231], a[12:15], a[44:47], v[228:231]
    ds_write_b128 v8, v[208:211] offset:36864
    v_mfma_f32_16x16x32_bf16 v[236:239], a[12:15], a[48:51], v[236:239]
    ds_write_b128 v8, v[216:219] offset:38912
    v_mfma_f32_16x16x32_bf16 v[224:227], a[16:19], a[48:51], v[224:227]
    ds_write_b128 v8, v[212:215] offset:37888
    v_mfma_f32_16x16x32_bf16 v[232:235], a[16:19], a[52:55], v[232:235]
    ds_write_b128 v8, v[220:223] offset:39936
    v_mfma_f32_16x16x32_bf16 v[228:231], a[20:23], a[48:51], v[228:231]
    v_mfma_f32_16x16x32_bf16 v[236:239], a[20:23], a[52:55], v[236:239]
    s_waitcnt vmcnt(16)
    v_mfma_f32_16x16x32_bf16 v[240:243], a[0:3], a[48:51], v[240:243]
    v_mfma_f32_16x16x32_bf16 v[248:251], a[0:3], a[52:55], v[248:251]
    v_mfma_f32_16x16x32_bf16 v[244:247], a[4:7], a[48:51], v[244:247]
    v_mfma_f32_16x16x32_bf16 v[252:255], a[4:7], a[52:55], v[252:255]
    v_mfma_f32_16x16x32_bf16 v[240:243], a[8:11], a[52:55], v[240:243]
    v_mfma_f32_16x16x32_bf16 v[248:251], a[8:11], a[56:59], v[248:251]
    v_mfma_f32_16x16x32_bf16 v[244:247], a[12:15], a[52:55], v[244:247]
    ds_write_b128 v9, v[224:227] offset:4096
    v_mfma_f32_16x16x32_bf16 v[252:255], a[12:15], a[56:59], v[252:255]
    ds_write_b128 v9, v[232:235] offset:6144
    v_mfma_f32_16x16x32_bf16 v[240:243], a[16:19], a[56:59], v[240:243]
    ds_write_b128 v9, v[228:231] offset:5120
    v_mfma_f32_16x16x32_bf16 v[248:251], a[16:19], a[60:63], v[248:251]
    ds_write_b128 v9, v[236:239] offset:7168
    v_mfma_f32_16x16x32_bf16 v[244:247], a[20:23], a[56:59], v[244:247]
    v_mfma_f32_16x16x32_bf16 v[252:255], a[20:23], a[60:63], v[252:255]
    s_add_u32 s62, s62, 0x60000
    s_add_u32 s63, s63, 0x60000
    s_add_u32 s64, s64, 0x60000
    s_add_u32 s65, s65, 36864
    s_waitcnt vmcnt(6)
    v_mfma_f32_16x16x32_bf16 v[128:131], a[64:67], a[88:91], v[128:131]
    buffer_load_dwordx4 a[128:131], v2, s[4:7], s65 offen offset:0 sc1
    v_mfma_f32_16x16x32_bf16 v[136:139], a[64:67], a[92:95], v[136:139]
    buffer_load_dwordx4 a[152:155], v2, s[4:7], s63 offen sc1
    v_mfma_f32_16x16x32_bf16 v[132:135], a[68:71], a[88:91], v[132:135]
    buffer_load_dwordx4 a[156:159], v2, s[4:7], s62 offen offset:0 sc1
    v_mfma_f32_16x16x32_bf16 v[140:143], a[68:71], a[92:95], v[140:143]
    buffer_load_dwordx4 a[132:135], v2, s[4:7], s65 offen offset:1024 sc1
    v_mfma_f32_16x16x32_bf16 v[128:131], a[72:75], a[92:95], v[128:131]
    buffer_load_dwordx4 a[136:139], v2, s[4:7], s65 offen offset:2048 sc1
    v_mfma_f32_16x16x32_bf16 v[136:139], a[72:75], a[96:99], v[136:139]
    buffer_load_dwordx4 a[160:163], v2, s[4:7], s62 offen offset:1024 sc1
    v_mfma_f32_16x16x32_bf16 v[132:135], a[76:79], a[92:95], v[132:135]
    buffer_load_dwordx4 a[140:143], v2, s[4:7], s65 offen offset:3072 sc1
    ds_write_b128 v9, v[240:243] offset:36864
    v_mfma_f32_16x16x32_bf16 v[140:143], a[76:79], a[96:99], v[140:143]
    buffer_load_dwordx4 a[144:147], v3, s[4:7], s65 offen offset:0 sc1
    ds_write_b128 v9, v[248:251] offset:38912
    v_mfma_f32_16x16x32_bf16 v[128:131], a[80:83], a[96:99], v[128:131]
    buffer_load_dwordx4 a[164:167], v2, s[4:7], s62 offen offset:2048 sc1
    ds_write_b128 v9, v[244:247] offset:37888
    v_mfma_f32_16x16x32_bf16 v[136:139], a[80:83], a[100:103], v[136:139]
    buffer_load_dwordx4 a[148:151], v3, s[4:7], s65 offen offset:1024 sc1
    ds_write_b128 v9, v[252:255] offset:39936
    v_mfma_f32_16x16x32_bf16 v[132:135], a[84:87], a[96:99], v[132:135]
    buffer_load_dwordx4 a[168:171], v2, s[4:7], s62 offen offset:3072 sc1
    v_mfma_f32_16x16x32_bf16 v[140:143], a[84:87], a[100:103], v[140:143]
    buffer_load_dwordx4 a[172:175], v3, s[4:7], s62 offen offset:0 sc1
    s_waitcnt vmcnt(16)
    v_mfma_f32_16x16x32_bf16 v[144:147], a[64:67], a[96:99], v[144:147]
    buffer_load_dwordx4 a[176:179], v3, s[4:7], s62 offen offset:1024 sc1
    v_mfma_f32_16x16x32_bf16 v[152:155], a[64:67], a[100:103], v[152:155]
    buffer_load_dwordx4 a[180:183], v3, s[4:7], s62 offen offset:2048 sc1
    v_mfma_f32_16x16x32_bf16 v[148:151], a[68:71], a[96:99], v[148:151]
    buffer_load_dwordx4 a[184:187], v3, s[4:7], s62 offen offset:3072 sc1
    v_mfma_f32_16x16x32_bf16 v[156:159], a[68:71], a[100:103], v[156:159]
    buffer_load_dwordx4 a[188:191], v2, s[4:7], s64 offen sc1
    v_mfma_f32_16x16x32_bf16 v[144:147], a[72:75], a[100:103], v[144:147]
    v_mfma_f32_16x16x32_bf16 v[152:155], a[72:75], a[104:107], v[152:155]
    v_mfma_f32_16x16x32_bf16 v[148:151], a[76:79], a[100:103], v[148:151]
    v_mfma_f32_16x16x32_bf16 v[156:159], a[76:79], a[104:107], v[156:159]
    v_mfma_f32_16x16x32_bf16 v[144:147], a[80:83], a[104:107], v[144:147]
    v_mfma_f32_16x16x32_bf16 v[152:155], a[80:83], a[108:111], v[152:155]
    v_mfma_f32_16x16x32_bf16 v[148:151], a[84:87], a[104:107], v[148:151]
    v_mfma_f32_16x16x32_bf16 v[156:159], a[84:87], a[108:111], v[156:159]
    s_waitcnt vmcnt(18)
    v_mfma_f32_16x16x32_bf16 v[160:163], a[64:67], a[104:107], v[160:163]
    v_mfma_f32_16x16x32_bf16 v[168:171], a[64:67], a[108:111], v[168:171]
    v_mfma_f32_16x16x32_bf16 v[164:167], a[68:71], a[104:107], v[164:167]
    v_mfma_f32_16x16x32_bf16 v[172:175], a[68:71], a[108:111], v[172:175]
    v_mfma_f32_16x16x32_bf16 v[160:163], a[72:75], a[108:111], v[160:163]
    v_mfma_f32_16x16x32_bf16 v[168:171], a[72:75], a[112:115], v[168:171]
    v_mfma_f32_16x16x32_bf16 v[164:167], a[76:79], a[108:111], v[164:167]
    v_mfma_f32_16x16x32_bf16 v[172:175], a[76:79], a[112:115], v[172:175]
    v_mfma_f32_16x16x32_bf16 v[160:163], a[80:83], a[112:115], v[160:163]
    v_mfma_f32_16x16x32_bf16 v[168:171], a[80:83], a[116:119], v[168:171]
    v_mfma_f32_16x16x32_bf16 v[164:167], a[84:87], a[112:115], v[164:167]
    v_mfma_f32_16x16x32_bf16 v[172:175], a[84:87], a[116:119], v[172:175]
    s_waitcnt vmcnt(16)
    s_branch L_x3
L_x3_back:
    v_mfma_f32_16x16x32_bf16 v[176:179], a[64:67], a[112:115], v[176:179]
    v_mfma_f32_16x16x32_bf16 v[184:187], a[64:67], a[116:119], v[184:187]
    v_mfma_f32_16x16x32_bf16 v[180:183], a[68:71], a[112:115], v[180:183]
    v_mfma_f32_16x16x32_bf16 v[188:191], a[68:71], a[116:119], v[188:191]
    v_mfma_f32_16x16x32_bf16 v[176:179], a[72:75], a[116:119], v[176:179]
    v_mfma_f32_16x16x32_bf16 v[184:187], a[72:75], a[120:123], v[184:187]
    v_mfma_f32_16x16x32_bf16 v[180:183], a[76:79], a[116:119], v[180:183]
    v_mfma_f32_16x16x32_bf16 v[188:191], a[76:79], a[120:123], v[188:191]
    v_mfma_f32_16x16x32_bf16 v[176:179], a[80:83], a[120:123], v[176:179]
    v_mfma_f32_16x16x32_bf16 v[184:187], a[80:83], a[124:127], v[184:187]
    v_mfma_f32_16x16x32_bf16 v[180:183], a[84:87], a[120:123], v[180:183]
    v_mfma_f32_16x16x32_bf16 v[188:191], a[84:87], a[124:127], v[188:191]
    s_waitcnt vmcnt(22)
    v_mfma_f32_16x16x32_bf16 v[128:131], a[128:131], a[152:155], v[128:131]
    v_mfma_f32_16x16x32_bf16 v[136:139], a[128:131], a[156:159], v[136:139]
    v_mfma_f32_16x16x32_bf16 v[132:135], a[132:135], a[152:155], v[132:135]
    v_mfma_f32_16x16x32_bf16 v[140:143], a[132:135], a[156:159], v[140:143]
    v_mfma_f32_16x16x32_bf16 v[128:131], a[136:139], a[156:159], v[128:131]
    v_mfma_f32_16x16x32_bf16 v[136:139], a[136:139], a[160:163], v[136:139]
    v_mfma_f32_16x16x32_bf16 v[132:135], a[140:143], a[156:159], v[132:135]
    v_mfma_f32_16x16x32_bf16 v[140:143], a[140:143], a[160:163], v[140:143]
    v_mfma_f32_16x16x32_bf16 v[128:131], a[144:147], a[160:163], v[128:131]
    v_mfma_f32_16x16x32_bf16 v[136:139], a[144:147], a[164:167], v[136:139]
    v_mfma_f32_16x16x32_bf16 v[132:135], a[148:151], a[160:163], v[132:135]
    v_mfma_f32_16x16x32_bf16 v[140:143], a[148:151], a[164:167], v[140:143]
    s_waitcnt vmcnt(20)
    v_mfma_f32_16x16x32_bf16 v[144:147], a[128:131], a[160:163], v[144:147]
    v_mfma_f32_16x16x32_bf16 v[152:155], a[128:131], a[164:167], v[152:155]
    v_mfma_f32_16x16x32_bf16 v[148:151], a[132:135], a[160:163], v[148:151]
    v_mfma_f32_16x16x32_bf16 v[156:159], a[132:135], a[164:167], v[156:159]
    v_mfma_f32_16x16x32_bf16 v[144:147], a[136:139], a[164:167], v[144:147]
    v_mfma_f32_16x16x32_bf16 v[152:155], a[136:139], a[168:171], v[152:155]
    v_mfma_f32_16x16x32_bf16 v[148:151], a[140:143], a[164:167], v[148:151]
    ds_write_b128 v8, v[128:131] offset:0
    v_mfma_f32_16x16x32_bf16 v[156:159], a[140:143], a[168:171], v[156:159]
    ds_write_b128 v8, v[136:139] offset:2048
    v_mfma_f32_16x16x32_bf16 v[144:147], a[144:147], a[168:171], v[144:147]
    ds_write_b128 v8, v[132:135] offset:1024
    v_mfma_f32_16x16x32_bf16 v[152:155], a[144:147], a[172:175], v[152:155]
    ds_write_b128 v8, v[140:143] offset:3072
    v_mfma_f32_16x16x32_bf16 v[148:151], a[148:151], a[168:171], v[148:151]
    v_mfma_f32_16x16x32_bf16 v[156:159], a[148:151], a[172:175], v[156:159]
    s_waitcnt vmcnt(18)
    v_mfma_f32_16x16x32_bf16 v[160:163], a[128:131], a[168:171], v[160:163]
    v_mfma_f32_16x16x32_bf16 v[168:171], a[128:131], a[172:175], v[168:171]
    v_mfma_f32_16x16x32_bf16 v[164:167], a[132:135], a[168:171], v[164:167]
    v_mfma_f32_16x16x32_bf16 v[172:175], a[132:135], a[172:175], v[172:175]
    v_mfma_f32_16x16x32_bf16 v[160:163], a[136:139], a[172:175], v[160:163]
    v_mfma_f32_16x16x32_bf16 v[168:171], a[136:139], a[176:179], v[168:171]
    v_mfma_f32_16x16x32_bf16 v[164:167], a[140:143], a[172:175], v[164:167]
    ds_write_b128 v8, v[144:147] offset:32768
    v_mfma_f32_16x16x32_bf16 v[172:175], a[140:143], a[176:179], v[172:175]
    ds_write_b128 v8, v[152:155] offset:34816
    v_mfma_f32_16x16x32_bf16 v[160:163], a[144:147], a[176:179], v[160:163]
    ds_write_b128 v8, v[148:151] offset:33792
    v_mfma_f32_16x16x32_bf16 v[168:171], a[144:147], a[180:183], v[168:171]
    ds_write_b128 v8, v[156:159] offset:35840
    v_mfma_f32_16x16x32_bf16 v[164:167], a[148:151], a[176:179], v[164:167]
    v_mfma_f32_16x16x32_bf16 v[172:175], a[148:151], a[180:183], v[172:175]
    s_waitcnt vmcnt(16)
    v_mfma_f32_16x16x32_bf16 v[176:179], a[128:131], a[176:179], v[176:179]
    v_mfma_f32_16x16x32_bf16 v[184:187], a[128:131], a[180:183], v[184:187]
    v_mfma_f32_16x16x32_bf16 v[180:183], a[132:135], a[176:179], v[180:183]
    v_mfma_f32_16x16x32_bf16 v[188:191], a[132:135], a[180:183], v[188:191]
    v_mfma_f32_16x16x32_bf16 v[176:179], a[136:139], a[180:183], v[176:179]
    v_mfma_f32_16x16x32_bf16 v[184:187], a[136:139], a[184:187], v[184:187]
    v_mfma_f32_16x16x32_bf16 v[180:183], a[140:143], a[180:183], v[180:183]
    ds_write_b128 v9, v[160:163] offset:0
    v_mfma_f32_16x16x32_bf16 v[188:191], a[140:143], a[184:187], v[188:191]
    ds_write_b128 v9, v[168:171] offset:2048
    v_mfma_f32_16x16x32_bf16 v[176:179], a[144:147], a[184:187], v[176:179]
    ds_write_b128 v9, v[164:167] offset:1024
    v_mfma_f32_16x16x32_bf16 v[184:187], a[144:147], a[188:191], v[184:187]
    ds_write_b128 v9, v[172:175] offset:3072
    v_mfma_f32_16x16x32_bf16 v[180:183], a[148:151], a[184:187], v[180:183]
    v_mfma_f32_16x16x32_bf16 v[188:191], a[148:151], a[188:191], v[188:191]
    s_mov_b32 s32, 0x3f4a4588
    s_mov_b32 s33, 0xbf06d905
    s_mov_b32 s34, 0x3e06d905
    s_mov_b32 s35, 0xbeca4588
    s_mov_b32 s36, 0x3e4a4588
    s_mov_b32 s37, 0xbe97b426
    s_mov_b32 s38, 0x3e97b426
    s_mov_b32 s39, 0xbe638e39
    s_mov_b32 s40, 0x3ee38e39
    s_mov_b32 s41, 0x40000000
    ds_write_b128 v9, v[176:179] offset:32768
    ds_write_b128 v9, v[184:187] offset:34816
    ds_write_b128 v9, v[180:183] offset:33792
    ds_write_b128 v9, v[188:191] offset:35840
    s_waitcnt lgkmcnt(0)
    s_barrier
    s_cmp_lg_u32 s60, 0
    s_cbranch_scc1 L_join
    v_lshlrev_b32 v97, 5, v5
    v_add_u32 v97, 131200, v97
    ds_read_b128 v[64:67], v97 offset:0
    ds_read_b128 v[68:71], v97 offset:16
    ds_read_b128 v[72:75], v97 offset:64
    ds_read_b128 v[76:79], v97 offset:80
    ds_read_b128 v[80:83], v97 offset:0
    ds_read_b128 v[84:87], v97 offset:16
    ds_read_b128 v[88:91], v97 offset:64
    ds_read_b128 v[92:95], v97 offset:80
    ds_read_b128 v[100:103], v97 offset:16
    ds_read_b128 v[104:107], v97 offset:64
    ds_read_b128 v[108:111], v97 offset:80
    ds_read_b128 v[112:115], v97 offset:0
    ds_read_b128 v[116:119], v97 offset:16
    ds_read_b128 v[120:123], v97 offset:64
    ds_read_b128 v[124:127], v97 offset:80
    ds_read_b128 v[96:99], v97
L_join:
    ds_read_b128 v[128:131], v10 offset:0
    ds_read_b128 v[132:135], v10 offset:4096
    ds_read_b128 v[136:139], v10 offset:8192
    ds_read_b128 v[140:143], v10 offset:12288
    ds_read_b128 v[144:147], v10 offset:16384
    ds_read_b128 v[148:151], v10 offset:20480
    ds_read_b128 v[152:155], v10 offset:24576
    ds_read_b128 v[156:159], v10 offset:28672
    ds_read_b128 v[160:163], v10 offset:256
    ds_read_b128 v[164:167], v10 offset:4352
    ds_read_b128 v[168:171], v10 offset:8448
    ds_read_b128 v[172:175], v10 offset:12544
    ds_read_b128 v[176:179], v10 offset:16640
    ds_read_b128 v[180:183], v10 offset:20736
    ds_read_b128 v[184:187], v10 offset:24832
    ds_read_b128 v[188:191], v10 offset:28928
    ds_read_b128 v[192:195], v10 offset:1024
    ds_read_b128 v[196:199], v10 offset:5120
    ds_read_b128 v[200:203], v10 offset:9216
    ds_read_b128 v[204:207], v10 offset:13312
    ds_read_b128 v[208:211], v10 offset:17408
    ds_read_b128 v[212:215], v10 offset:21504
    ds_read_b128 v[216:219], v10 offset:25600
    ds_read_b128 v[220:223], v10 offset:29696
    ds_read_b128 v[224:227], v10 offset:1280
    ds_read_b128 v[228:231], v10 offset:5376
    ds_read_b128 v[232:235], v10 offset:9472
    ds_read_b128 v[236:239], v10 offset:13568
    ds_read_b128 v[240:243], v10 offset:17664
    ds_read_b128 v[244:247], v10 offset:21760
    ds_read_b128 v[248:251], v10 offset:25856
    ds_read_b128 v[252:255], v10 offset:29952
    s_cmp_eq_u32 s60, 0
    s_cbranch_scc1 L_noxu
    s_waitcnt vmcnt(0)
    v_lshlrev_b32 v64, 16, v16
    v_and_b32 v80, 0xffff0000, v16
    v_lshlrev_b32 v96, 16, v17
    v_and_b32 v112, 0xffff0000, v17
    v_lshlrev_b32 v65, 16, v18
    v_and_b32 v81, 0xffff0000, v18
    v_lshlrev_b32 v97, 16, v19
    v_and_b32 v113, 0xffff0000, v19
    v_lshlrev_b32 v66, 16, v20
    v_and_b32 v82, 0xffff0000, v20
    v_lshlrev_b32 v98, 16, v21
    v_and_b32 v114, 0xffff0000, v21
    v_lshlrev_b32 v67, 16, v22
    v_and_b32 v83, 0xffff0000, v22
    v_lshlrev_b32 v99, 16, v23
    v_and_b32 v115, 0xffff0000, v23
    v_lshlrev_b32 v68, 16, v24
    v_and_b32 v84, 0xffff0000, v24
    v_lshlrev_b32 v100, 16, v25
    v_and_b32 v116, 0xffff0000, v25
    v_lshlrev_b32 v69, 16, v26
    v_and_b32 v85, 0xffff0000, v26
    v_lshlrev_b32 v101, 16, v27
    v_and_b32 v117, 0xffff0000, v27
    v_lshlrev_b32 v70, 16, v28
    v_and_b32 v86, 0xffff0000, v28
    v_lshlrev_b32 v102, 16, v29
    v_and_b32 v118, 0xffff0000, v29
    v_lshlrev_b32 v71, 16, v30
    v_and_b32 v87, 0xffff0000, v30
    v_lshlrev_b32 v103, 16, v31
    v_and_b32 v119, 0xffff0000, v31
    v_lshlrev_b32 v72, 16, v32
    v_and_b32 v88, 0xffff0000, v32
    v_lshlrev_b32 v104, 16, v33
    v_and_b32 v120, 0xffff0000, v33
    v_lshlrev_b32 v73, 16, v34
    v_and_b32 v89, 0xffff0000, v34
    v_lshlrev_b32 v105, 16, v35
    v_and_b32 v121, 0xffff0000, v35
    v_lshlrev_b32 v74, 16, v36
    v_and_b32 v90, 0xffff0000, v36
    v_lshlrev_b32 v106, 16, v37
    v_and_b32 v122, 0xffff0000, v37
    v_lshlrev_b32 v75, 16, v38
    v_and_b32 v91, 0xffff0000, v38
    v_lshlrev_b32 v107, 16, v39
    v_and_b32 v123, 0xffff0000, v39
    v_lshlrev_b32 v76, 16, v40
    v_and_b32 v92, 0xffff0000, v40
    v_lshlrev_b32 v108, 16, v41
    v_and_b32 v124, 0xffff0000, v41
    v_lshlrev_b32 v77, 16, v42
    v_and_b32 v93, 0xffff0000, v42
    v_lshlrev_b32 v109, 16, v43
    v_and_b32 v125, 0xffff0000, v43
    v_lshlrev_b32 v78, 16, v44
    v_and_b32 v94, 0xffff0000, v44
    v_lshlrev_b32 v110, 16, v45
    v_and_b32 v126, 0xffff0000, v45
    v_lshlrev_b32 v79, 16, v46
    v_and_b32 v95, 0xffff0000, v46
    v_lshlrev_b32 v111, 16, v47
    v_and_b32 v127, 0xffff0000, v47
L_noxu:
    s_waitcnt lgkmcnt(15)
    v_pk_add_f32 v[128:129], v[128:129], v[136:137] neg_lo:[0,1] neg_hi:[0,1]
    v_pk_add_f32 v[144:145], v[144:145], v[152:153] neg_lo:[0,1] neg_hi:[0,1]
    v_pk_add_f32 v[132:133], v[132:133], v[140:141]
    v_pk_add_f32 v[148:149], v[148:149], v[156:157]
    v_pk_fma_f32 v[136:137], v[136:137], s[40:41], v[128:129] op_sel:[0,1,0] op_sel_hi:[1,1,1]
    v_pk_fma_f32 v[152:153], v[152:153], s[40:41], v[144:145] op_sel:[0,1,0] op_sel_hi:[1,1,1]
    v_pk_fma_f32 v[80:81], v[128:129], s[34:35], v[80:81] op_sel:[0,1,0] op_sel_hi:[1,1,1]
    v_pk_fma_f32 v[112:113], v[128:129], s[38:39], v[112:113] op_sel:[0,1,0] op_sel_hi:[1,1,1]
    v_pk_fma_f32 v[64:65], v[136:137], s[32:33], v[64:65] op_sel:[0,1,0] op_sel_hi:[1,1,1]
    v_pk_fma_f32 v[96:97], v[136:137], s[36:37], v[96:97] op_sel:[0,1,0] op_sel_hi:[1,1,1]
    v_pk_fma_f32 v[80:81], v[144:145], s[36:37], v[80:81] op_sel:[0,0,0] op_sel_hi:[1,0,1]
    v_pk_fma_f32 v[112:113], v[144:145], s[40:41], v[112:113] op_sel:[0,0,0] op_sel_hi:[1,0,1]
    v_pk_fma_f32 v[64:65], v[152:153], s[34:35], v[64:65] op_sel:[0,0,0] op_sel_hi:[1,0,1]
    v_pk_fma_f32 v[96:97], v[152:153], s[38:39], v[96:97] op_sel:[0,0,0] op_sel_hi:[1,0,1]
    v_pk_fma_f32 v[64:65], v[132:133], s[32:33], v[64:65] op_sel:[0,0,0] op_sel_hi:[1,0,1]
    v_pk_add_f32 v[112:113], v[112:113], v[148:149]
    v_pk_add_f32 v[130:131], v[130:131], v[138:139] neg_lo:[0,1] neg_hi:[0,1]
    v_pk_add_f32 v[146:147], v[146:147], v[154:155] neg_lo:[0,1] neg_hi:[0,1]
    v_pk_add_f32 v[134:135], v[134:135], v[142:143]
    v_pk_add_f32 v[150:151], v[150:151], v[158:159]
    v_pk_fma_f32 v[138:139], v[138:139], s[40:41], v[130:131] op_sel:[0,1,0] op_sel_hi:[1,1,1]
    v_pk_fma_f32 v[154:155], v[154:155], s[40:41], v[146:147] op_sel:[0,1,0] op_sel_hi:[1,1,1]
    v_pk_fma_f32 v[82:83], v[130:131], s[34:35], v[82:83] op_sel:[0,1,0] op_sel_hi:[1,1,1]
    v_pk_fma_f32 v[114:115], v[130:131], s[38:39], v[114:115] op_sel:[0,1,0] op_sel_hi:[1,1,1]
    v_pk_fma_f32 v[66:67], v[138:139], s[32:33], v[66:67] op_sel:[0,1,0] op_sel_hi:[1,1,1]
    v_pk_fma_f32 v[98:99], v[138:139], s[36:37], v[98:99] op_sel:[0,1,0] op_sel_hi:[1,1,1]
    v_pk_fma_f32 v[82:83], v[146:147], s[36:37], v[82:83] op_sel:[0,0,0] op_sel_hi:[1,0,1]
    v_pk_fma_f32 v[114:115], v[146:147], s[40:41], v[114:115] op_sel:[0,0,0] op_sel_hi:[1,0,1]
    v_pk_fma_f32 v[66:67], v[154:155], s[34:35], v[66:67] op_sel:[0,0,0] op_sel_hi:[1,0,1]
    v_pk_fma_f32 v[98:99], v[154:155], s[38:39], v[98:99] op_sel:[0,0,0] op_sel_hi:[1,0,1]
    v_pk_fma_f32 v[66:67], v[134:135], s[32:33], v[66:67] op_sel:[0,0,0] op_sel_hi:[1,0,1]
    v_pk_add_f32 v[114:115], v[114:115], v[150:151]
    s_cmp_eq_u32 s60, 0
    s_cbranch_scc1 L_nost0
    v_cvt_pk_bf16_f32 v16, v64, v80
    v_cvt_pk_bf16_f32 v17, v96, v112
    s_add_u32 s72, s67, 0
    buffer_store_dwordx2 v[16:17], v7, s[28:31], s72 offen sc0 sc1
    v_cvt_pk_bf16_f32 v18, v65, v81
    v_cvt_pk_bf16_f32 v19, v97, v113
    s_add_u32 s72, s67, 8192
    buffer_store_dwordx2 v[18:19], v7, s[28:31], s72 offen sc0 sc1
    v_cvt_pk_bf16_f32 v20, v66, v82
    v_cvt_pk_bf16_f32 v21, v98, v114
    s_add_u32 s72, s67, 16384
    buffer_store_dwordx2 v[20:21], v7, s[28:31], s72 offen sc0 sc1
    v_cvt_pk_bf16_f32 v22, v67, v83
    v_cvt_pk_bf16_f32 v23, v99, v115
    s_add_u32 s72, s67, 24576
    buffer_store_dwordx2 v[22:23], v7, s[28:31], s72 offen sc0 sc1
L_nost0:
    s_waitcnt lgkmcnt(15)
    v_pk_add_f32 v[160:161], v[160:161], v[168:169] neg_lo:[0,1] neg_hi:[0,1]
    v_pk_add_f32 v[176:177], v[176:177], v[184:185] neg_lo:[0,1] neg_hi:[0,1]
    v_pk_add_f32 v[164:165], v[164:165], v[172:173]
    v_pk_add_f32 v[180:181], v[180:181], v[188:189]
    v_pk_fma_f32 v[168:169], v[168:169], s[40:41], v[160:161] op_sel:[0,1,0] op_sel_hi:[1,1,1]
    v_pk_fma_f32 v[184:185], v[184:185], s[40:41], v[176:177] op_sel:[0,1,0] op_sel_hi:[1,1,1]
    v_pk_fma_f32 v[84:85], v[160:161], s[34:35], v[84:85] op_sel:[0,1,0] op_sel_hi:[1,1,1]
    v_pk_fma_f32 v[116:117], v[160:161], s[38:39], v[116:117] op_sel:[0,1,0] op_sel_hi:[1,1,1]
    v_pk_fma_f32 v[68:69], v[168:169], s[32:33], v[68:69] op_sel:[0,1,0] op_sel_hi:[1,1,1]
    v_pk_fma_f32 v[100:101], v[168:169], s[36:37], v[100:101] op_sel:[0,1,0] op_sel_hi:[1,1,1]
    v_pk_fma_f32 v[84:85], v[176:177], s[36:37], v[84:85] op_sel:[0,0,0] op_sel_hi:[1,0,1]
    v_pk_fma_f32 v[116:117], v[176:177], s[40:41], v[116:117] op_sel:[0,0,0] op_sel_hi:[1,0,1]
    v_pk_fma_f32 v[68:69], v[184:185], s[34:35], v[68:69] op_sel:[0,0,0] op_sel_hi:[1,0,1]
    v_pk_fma_f32 v[100:101], v[184:185], s[38:39], v[100:101] op_sel:[0,0,0] op_sel_hi:[1,0,1]
    v_pk_fma_f32 v[68:69], v[164:165], s[32:33], v[68:69] op_sel:[0,0,0] op_sel_hi:[1,0,1]
    v_pk_add_f32 v[116:117], v[116:117], v[180:181]
    v_pk_add_f32 v[162:163], v[162:163], v[170:171] neg_lo:[0,1] neg_hi:[0,1]
    v_pk_add_f32 v[178:179], v[178:179], v[186:187] neg_lo:[0,1] neg_hi:[0,1]
    v_pk_add_f32 v[166:167], v[166:167], v[174:175]
    v_pk_add_f32 v[182:183], v[182:183], v[190:191]
    v_pk_fma_f32 v[170:171], v[170:171], s[40:41], v[162:163] op_sel:[0,1,0] op_sel_hi:[1,1,1]
    v_pk_fma_f32 v[186:187], v[186:187], s[40:41], v[178:179] op_sel:[0,1,0] op_sel_hi:[1,1,1]
    v_pk_fma_f32 v[86:87], v[162:163], s[34:35], v[86:87] op_sel:[0,1,0] op_sel_hi:[1,1,1]
    v_pk_fma_f32 v[118:119], v[162:163], s[38:39], v[118:119] op_sel:[0,1,0] op_sel_hi:[1,1,1]
    v_pk_fma_f32 v[70:71], v[170:171], s[32:33], v[70:71] op_sel:[0,1,0] op_sel_hi:[1,1,1]
    v_pk_fma_f32 v[102:103], v[170:171], s[36:37], v[102:103] op_sel:[0,1,0] op_sel_hi:[1,1,1]
    v_pk_fma_f32 v[86:87], v[178:179], s[36:37], v[86:87] op_sel:[0,0,0] op_sel_hi:[1,0,1]
    v_pk_fma_f32 v[118:119], v[178:179], s[40:41], v[118:119] op_sel:[0,0,0] op_sel_hi:[1,0,1]
    v_pk_fma_f32 v[70:71], v[186:187], s[34:35], v[70:71] op_sel:[0,0,0] op_sel_hi:[1,0,1]
    v_pk_fma_f32 v[102:103], v[186:187], s[38:39], v[102:103] op_sel:[0,0,0] op_sel_hi:[1,0,1]
    v_pk_fma_f32 v[70:71], v[166:167], s[32:33], v[70:71] op_sel:[0,0,0] op_sel_hi:[1,0,1]
    v_pk_add_f32 v[118:119], v[118:119], v[182:183]
    s_cmp_eq_u32 s60, 0
    s_cbranch_scc1 L_nost1
    v_cvt_pk_bf16_f32 v24, v68, v84
    v_cvt_pk_bf16_f32 v25, v100, v116
    s_add_u32 s72, s67, 32768
    buffer_store_dwordx2 v[24:25], v7, s[28:31], s72 offen sc0 sc1
    v_cvt_pk_bf16_f32 v26, v69, v85
    v_cvt_pk_bf16_f32 v27, v101, v117
    s_add_u32 s72, s67, 40960
    buffer_store_dwordx2 v[26:27], v7, s[28:31], s72 offen sc0 sc1
    v_cvt_pk_bf16_f32 v28, v70, v86
    v_cvt_pk_bf16_f32 v29, v102, v118
    s_add_u32 s72, s67, 49152
    buffer_store_dwordx2 v[28:29], v7, s[28:31], s72 offen sc0 sc1
    v_cvt_pk_bf16_f32 v30, v71, v87
    v_cvt_pk_bf16_f32 v31, v103, v119
    s_add_u32 s72, s67, 57344
    buffer_store_dwordx2 v[30:31], v7, s[28:31], s72 offen sc0 sc1
L_nost1:
    s_waitcnt lgkmcnt(8)
    v_pk_add_f32 v[192:193], v[192:193], v[200:201] neg_lo:[0,1] neg_hi:[0,1]
    v_pk_add_f32 v[208:209], v[208:209], v[216:217] neg_lo:[0,1] neg_hi:[0,1]
    v_pk_add_f32 v[196:197], v[196:197], v[204:205]
    v_pk_add_f32 v[212:213], v[212:213], v[220:221]
    v_pk_fma_f32 v[200:201], v[200:201], s[40:41], v[192:193] op_sel:[0,1,0] op_sel_hi:[1,1,1]
    v_pk_fma_f32 v[216:217], v[216:217], s[40:41], v[208:209] op_sel:[0,1,0] op_sel_hi:[1,1,1]
    v_pk_fma_f32 v[88:89], v[192:193], s[34:35], v[88:89] op_sel:[0,1,0] op_sel_hi:[1,1,1]
    v_pk_fma_f32 v[120:121], v[192:193], s[38:39], v[120:121] op_sel:[0,1,0] op_sel_hi:[1,1,1]
    v_pk_fma_f32 v[72:73], v[200:201], s[32:33], v[72:73] op_sel:[0,1,0] op_sel_hi:[1,1,1]
    v_pk_fma_f32 v[104:105], v[200:201], s[36:37], v[104:105] op_sel:[0,1,0] op_sel_hi:[1,1,1]
    v_pk_fma_f32 v[88:89], v[208:209], s[36:37], v[88:89] op_sel:[0,0,0] op_sel_hi:[1,0,1]
    v_pk_fma_f32 v[120:121], v[208:209], s[40:41], v[120:121] op_sel:[0,0,0] op_sel_hi:[1,0,1]
    v_pk_fma_f32 v[72:73], v[216:217], s[34:35], v[72:73] op_sel:[0,0,0] op_sel_hi:[1,0,1]
    v_pk_fma_f32 v[104:105], v[216:217], s[38:39], v[104:105] op_sel:[0,0,0] op_sel_hi:[1,0,1]
    v_pk_fma_f32 v[72:73], v[196:197], s[32:33], v[72:73] op_sel:[0,0,0] op_sel_hi:[1,0,1]
    v_pk_add_f32 v[120:121], v[120:121], v[212:213]
    v_pk_add_f32 v[194:195], v[194:195], v[202:203] neg_lo:[0,1] neg_hi:[0,1]
    v_pk_add_f32 v[210:211], v[210:211], v[218:219] neg_lo:[0,1] neg_hi:[0,1]
    v_pk_add_f32 v[198:199], v[198:199], v[206:207]
    v_pk_add_f32 v[214:215], v[214:215], v[222:223]
    v_pk_fma_f32 v[202:203], v[202:203], s[40:41], v[194:195] op_sel:[0,1,0] op_sel_hi:[1,1,1]
    v_pk_fma_f32 v[218:219], v[218:219], s[40:41], v[210:211] op_sel:[0,1,0] op_sel_hi:[1,1,1]
    v_pk_fma_f32 v[90:91], v[194:195], s[34:35], v[90:91] op_sel:[0,1,0] op_sel_hi:[1,1,1]
    v_pk_fma_f32 v[122:123], v[194:195], s[38:39], v[122:123] op_sel:[0,1,0] op_sel_hi:[1,1,1]
    v_pk_fma_f32 v[74:75], v[202:203], s[32:33], v[74:75] op_sel:[0,1,0] op_sel_hi:[1,1,1]
    v_pk_fma_f32 v[106:107], v[202:203], s[36:37], v[106:107] op_sel:[0,1,0] op_sel_hi:[1,1,1]
    v_pk_fma_f32 v[90:91], v[210:211], s[36:37], v[90:91] op_sel:[0,0,0] op_sel_hi:[1,0,1]
    v_pk_fma_f32 v[122:123], v[210:211], s[40:41], v[122:123] op_sel:[0,0,0] op_sel_hi:[1,0,1]
    v_pk_fma_f32 v[74:75], v[218:219], s[34:35], v[74:75] op_sel:[0,0,0] op_sel_hi:[1,0,1]
    v_pk_fma_f32 v[106:107], v[218:219], s[38:39], v[106:107] op_sel:[0,0,0] op_sel_hi:[1,0,1]
    v_pk_fma_f32 v[74:75], v[198:199], s[32:33], v[74:75] op_sel:[0,0,0] op_sel_hi:[1,0,1]
    v_pk_add_f32 v[122:123], v[122:123], v[214:215]
    s_cmp_eq_u32 s60, 0
    s_cbranch_scc1 L_nost2
    v_cvt_pk_bf16_f32 v32, v72, v88
    v_cvt_pk_bf16_f32 v33, v104, v120
    s_add_u32 s72, s67, 131072
    buffer_store_dwordx2 v[32:33], v7, s[28:31], s72 offen sc0 sc1
    v_cvt_pk_bf16_f32 v34, v73, v89
    v_cvt_pk_bf16_f32 v35, v105, v121
    s_add_u32 s72, s67, 139264
    buffer_store_dwordx2 v[34:35], v7, s[28:31], s72 offen sc0 sc1
    v_cvt_pk_bf16_f32 v36, v74, v90
    v_cvt_pk_bf16_f32 v37, v106, v122
    s_add_u32 s72, s67, 147456
    buffer_store_dwordx2 v[36:37], v7, s[28:31], s72 offen sc0 sc1
    v_cvt_pk_bf16_f32 v38, v75, v91
    v_cvt_pk_bf16_f32 v39, v107, v123
    s_add_u32 s72, s67, 155648
    buffer_store_dwordx2 v[38:39], v7, s[28:31], s72 offen sc0 sc1
L_nost2:
    s_waitcnt lgkmcnt(0)
    v_pk_add_f32 v[224:225], v[224:225], v[232:233] neg_lo:[0,1] neg_hi:[0,1]
    v_pk_add_f32 v[240:241], v[240:241], v[248:249] neg_lo:[0,1] neg_hi:[0,1]
    v_pk_add_f32 v[228:229], v[228:229], v[236:237]
    v_pk_add_f32 v[244:245], v[244:245], v[252:253]
    v_pk_fma_f32 v[232:233], v[232:233], s[40:41], v[224:225] op_sel:[0,1,0] op_sel_hi:[1,1,1]
    v_pk_fma_f32 v[248:249], v[248:249], s[40:41], v[240:241] op_sel:[0,1,0] op_sel_hi:[1,1,1]
    v_pk_fma_f32 v[92:93], v[224:225], s[34:35], v[92:93] op_sel:[0,1,0] op_sel_hi:[1,1,1]
    v_pk_fma_f32 v[124:125], v[224:225], s[38:39], v[124:125] op_sel:[0,1,0] op_sel_hi:[1,1,1]
    v_pk_fma_f32 v[76:77], v[232:233], s[32:33], v[76:77] op_sel:[0,1,0] op_sel_hi:[1,1,1]
    v_pk_fma_f32 v[108:109], v[232:233], s[36:37], v[108:109] op_sel:[0,1,0] op_sel_hi:[1,1,1]
    v_pk_fma_f32 v[92:93], v[240:241], s[36:37], v[92:93] op_sel:[0,0,0] op_sel_hi:[1,0,1]
    v_pk_fma_f32 v[124:125], v[240:241], s[40:41], v[124:125] op_sel:[0,0,0] op_sel_hi:[1,0,1]
    v_pk_fma_f32 v[76:77], v[248:249], s[34:35], v[76:77] op_sel:[0,0,0] op_sel_hi:[1,0,1]
    v_pk_fma_f32 v[108:109], v[248:249], s[38:39], v[108:109] op_sel:[0,0,0] op_sel_hi:[1,0,1]
    v_pk_fma_f32 v[76:77], v[228:229], s[32:33], v[76:77] op_sel:[0,0,0] op_sel_hi:[1,0,1]
    v_pk_add_f32 v[124:125], v[124:125], v[244:245]
    v_pk_add_f32 v[226:227], v[226:227], v[234:235] neg_lo:[0,1] neg_hi:[0,1]
    v_pk_add_f32 v[242:243], v[242:243], v[250:251] neg_lo:[0,1] neg_hi:[0,1]
    v_pk_add_f32 v[230:231], v[230:231], v[238:239]
    v_pk_add_f32 v[246:247], v[246:247], v[254:255]
    v_pk_fma_f32 v[234:235], v[234:235], s[40:41], v[226:227] op_sel:[0,1,0] op_sel_hi:[1,1,1]
    v_pk_fma_f32 v[250:251], v[250:251], s[40:41], v[242:243] op_sel:[0,1,0] op_sel_hi:[1,1,1]
    v_pk_fma_f32 v[94:95], v[226:227], s[34:35], v[94:95] op_sel:[0,1,0] op_sel_hi:[1,1,1]
    v_pk_fma_f32 v[126:127], v[226:227], s[38:39], v[126:127] op_sel:[0,1,0] op_sel_hi:[1,1,1]
    v_pk_fma_f32 v[78:79], v[234:235], s[32:33], v[78:79] op_sel:[0,1,0] op_sel_hi:[1,1,1]
    v_pk_fma_f32 v[110:111], v[234:235], s[36:37], v[110:111] op_sel:[0,1,0] op_sel_hi:[1,1,1]
    v_pk_fma_f32 v[94:95], v[242:243], s[36:37], v[94:95] op_sel:[0,0,0] op_sel_hi:[1,0,1]
    v_pk_fma_f32 v[126:127], v[242:243], s[40:41], v[126:127] op_sel:[0,0,0] op_sel_hi:[1,0,1]
    v_pk_fma_f32 v[78:79], v[250:251], s[34:35], v[78:79] op_sel:[0,0,0] op_sel_hi:[1,0,1]
    v_pk_fma_f32 v[110:111], v[250:251], s[38:39], v[110:111] op_sel:[0,0,0] op_sel_hi:[1,0,1]
    v_pk_fma_f32 v[78:79], v[230:231], s[32:33], v[78:79] op_sel:[0,0,0] op_sel_hi:[1,0,1]
    v_pk_add_f32 v[126:127], v[126:127], v[246:247]
    s_cmp_eq_u32 s60, 0
    s_cbranch_scc1 L_nost3
    v_cvt_pk_bf16_f32 v40, v76, v92
    v_cvt_pk_bf16_f32 v41, v108, v124
    s_add_u32 s72, s67, 163840
    buffer_store_dwordx2 v[40:41], v7, s[28:31], s72 offen sc0 sc1
    v_cvt_pk_bf16_f32 v42, v77, v93
    v_cvt_pk_bf16_f32 v43, v109, v125
    s_add_u32 s72, s67, 172032
    buffer_store_dwordx2 v[42:43], v7, s[28:31], s72 offen sc0 sc1
    v_cvt_pk_bf16_f32 v44, v78, v94
    v_cvt_pk_bf16_f32 v45, v110, v126
    s_add_u32 s72, s67, 180224
    buffer_store_dwordx2 v[44:45], v7, s[28:31], s72 offen sc0 sc1
    v_cvt_pk_bf16_f32 v46, v79, v95
    v_cvt_pk_bf16_f32 v47, v111, v127
    s_add_u32 s72, s67, 188416
    buffer_store_dwordx2 v[46:47], v7, s[28:31], s72 offen sc0 sc1
    s_branch L_final
L_nost3:
    s_mov_b32 s60, 1
    s_mov_b32 s66, 0x1800000
    s_add_u32 s86, s86, 0x1800000
    s_add_u32 s69, s69, 0x1800000
    s_mul_i32 s79, s58, 6291456
    s_lshr_b32 s73, s57, 1
    s_mul_i32 s73, s73, 393216
    s_add_u32 s79, s79, s73
    s_lshl_b32 s73, s59, 10
    s_add_u32 s79, s79, s73
    s_lshl_b32 s73, s3, 11
    s_add_u32 s79, s79, s73
    s_and_b32 s73, s57, 1
    s_lshl_b32 s73, s73, 9
    s_add_u32 s79, s79, s73
    s_add_u32 s79, s79, s66
    s_lshl_b32 s78, s58, 2
    s_lshr_b32 s73, s57, 2
    s_add_u32 s78, s78, s73
    s_lshl_b32 s78, s78, 12
    s_add_u32 s78, s78, 0x1740000
    s_add_u32 s78, s78, s66
    s_and_b32 s96, s57, 3
    s_lshl_b32 s96, s96, 6
    s_add_u32 s96, s96, s59
    s_lshl_b32 s96, s96, 4
    s_add_u32 s96, s96, s78
    s_lshl_b32 s73, s56, 8
    s_lshl_b32 s74, s57, 3
    s_add_u32 s73, s73, s74
    v_writelane_b32 v12, s73, 0
    s_branch L_layer
L_final:
L_end:
    s_endpgm
L_resolve:
    s_waitcnt vmcnt(1)
    v_readfirstlane_b32 s61, v169
    s_mov_b32 s71, 100000
    s_nop 2
    s_cmp_lg_u32 s61, 0
    s_cbranch_scc1 L_havetag
L_npoll:
    s_waitcnt vmcnt(0)
    v_readfirstlane_b32 s61, v168
    s_sub_u32 s71, s71, 1
    s_nop 2
    s_cmp_lg_u32 s61, 0
    s_cbranch_scc1 L_havetag
    buffer_load_dword v168, v14, s[24:27], 0 offen sc1
    s_cmp_lg_u32 s71, 0
    s_cbranch_scc1 L_npoll
    s_mov_b32 s61, 1
L_havetag:
    v_mov_b32 v170, s97
    v_mov_b32 v171, s61
    s_lshl_b32 s72, s2, 3
    s_add_u32 s72, s72, 0x170c000
    s_mov_b64 exec, 1
    buffer_store_dwordx2 v[170:171], v14, s[4:7], s72 offen sc0 sc1
    s_mov_b64 exec, -1
    s_branch L_resolve_back
L_tpoll:
    s_mov_b32 s72, 0x170c000
    v_lshlrev_b32 v8, 1, v2
    buffer_load_dwordx4 v[56:59], v8, s[4:7], s72 offen sc1
    buffer_load_dwordx4 v[60:63], v8, s[4:7], s72 offen offset:16 sc1
    s_sub_u32 s71, s71, 1
    s_waitcnt vmcnt(0)
    s_cmp_lg_u32 s71, 0
    s_cbranch_scc1 L_tchk
    s_branch L_tok
L_fl1_ld:
    buffer_load_dwordx2 v[60:61], v1, s[4:7], s75 offen sc1
    s_branch L_fl1_back
L_fl1_st:
    s_cmp_lg_u32 s3, 1
    s_cbranch_scc1 L_fl1st_back
    s_mov_b64 exec, 3
    buffer_store_dwordx2 v[56:57], v12, s[4:7], s75 offen sc0 sc1
    s_mov_b64 exec, -1
    s_cmp_eq_u32 s94, 0
    s_cbranch_scc1 L_fl1st_back
    v_add_f32_dpp v88, v88, v88 quad_perm:[1,0,3,2] row_mask:0xf bank_mask:0xf
    v_add_f32_dpp v89, v89, v89 quad_perm:[1,0,3,2] row_mask:0xf bank_mask:0xf
    v_add_f32_dpp v90, v90, v90 quad_perm:[1,0,3,2] row_mask:0xf bank_mask:0xf
    v_add_f32_dpp v91, v91, v91 quad_perm:[1,0,3,2] row_mask:0xf bank_mask:0xf
    v_add_f32_dpp v92, v92, v92 quad_perm:[1,0,3,2] row_mask:0xf bank_mask:0xf
    v_add_f32_dpp v93, v93, v93 quad_perm:[1,0,3,2] row_mask:0xf bank_mask:0xf
    v_add_f32_dpp v94, v94, v94 quad_perm:[1,0,3,2] row_mask:0xf bank_mask:0xf
    v_add_f32_dpp v95, v95, v95 quad_perm:[1,0,3,2] row_mask:0xf bank_mask:0xf
    v_add_f32_dpp v88, v88, v88 quad_perm:[2,3,0,1] row_mask:0xf bank_mask:0xf
    v_add_f32_dpp v89, v89, v89 quad_perm:[2,3,0,1] row_mask:0xf bank_mask:0xf
    v_add_f32_dpp v90, v90, v90 quad_perm:[2,3,0,1] row_mask:0xf bank_mask:0xf
    v_add_f32_dpp v91, v91, v91 quad_perm:[2,3,0,1] row_mask:0xf bank_mask:0xf
    v_add_f32_dpp v92, v92, v92 quad_perm:[2,3,0,1] row_mask:0xf bank_mask:0xf
    v_add_f32_dpp v93, v93, v93 quad_perm:[2,3,0,1] row_mask:0xf bank_mask:0xf
    v_add_f32_dpp v94, v94, v94 quad_perm:[2,3,0,1] row_mask:0xf bank_mask:0xf
    v_add_f32_dpp v95, v95, v95 quad_perm:[2,3,0,1] row_mask:0xf bank_mask:0xf
    v_add_f32_dpp v88, v88, v88 row_half_mirror row_mask:0xf bank_mask:0xf
    v_add_f32_dpp v89, v89, v89 row_half_mirror row_mask:0xf bank_mask:0xf
    v_add_f32_dpp v90, v90, v90 row_half_mirror row_mask:0xf bank_mask:0xf
    v_add_f32_dpp v91, v91, v91 row_half_mirror row_mask:0xf bank_mask:0xf
    v_add_f32_dpp v92, v92, v92 row_half_mirror row_mask:0xf bank_mask:0xf
    v_add_f32_dpp v93, v93, v93 row_half_mirror row_mask:0xf bank_mask:0xf
    v_add_f32_dpp v94, v94, v94 row_half_mirror row_mask:0xf bank_mask:0xf
    v_add_f32_dpp v95, v95, v95 row_half_mirror row_mask:0xf bank_mask:0xf
    v_add_f32_dpp v88, v88, v88 row_mirror row_mask:0xf bank_mask:0xf
    v_add_f32_dpp v89, v89, v89 row_mirror row_mask:0xf bank_mask:0xf
    v_add_f32_dpp v90, v90, v90 row_mirror row_mask:0xf bank_mask:0xf
    v_add_f32_dpp v91, v91, v91 row_mirror row_mask:0xf bank_mask:0xf
    v_add_f32_dpp v92, v92, v92 row_mirror row_mask:0xf bank_mask:0xf
    v_add_f32_dpp v93, v93, v93 row_mirror row_mask:0xf bank_mask:0xf
    v_add_f32_dpp v94, v94, v94 row_mirror row_mask:0xf bank_mask:0xf
    v_add_f32_dpp v95, v95, v95 row_mirror row_mask:0xf bank_mask:0xf
    ds_write_b128 v96, v[88:91]
    ds_write_b128 v96, v[92:95] offset:16
    s_branch L_fl1st_back
L_chk:
    s_mov_b32 s94, 100000
    s_waitcnt vmcnt(16)
L_chk_loop:
    v_cmp_ne_u32 vcc, s61, v60
    v_cmp_ne_u32 s[80:81], s61, v61
    s_nop 1
    s_or_b64 s[80:81], s[80:81], vcc
    s_cbranch_scc0 L_chk_back
    buffer_load_dwordx2 v[60:61], v1, s[4:7], s75 offen sc1
    s_sub_u32 s94, s94, 1
    s_waitcnt vmcnt(0)
    s_cmp_lg_u32 s94, 0
    s_cbranch_scc1 L_chk_loop
    s_branch L_chk_back
L_pre:
    s_mov_b32 s8, s44
    s_and_b32 s9, s45, 0xffff
    s_mov_b32 s10, 0x400
    s_mov_b32 s11, 0x20000
    s_mov_b32 s12, s46
    s_and_b32 s13, s47, 0xffff
    s_mov_b32 s14, 0x400
    s_mov_b32 s15, 0x20000
    s_mov_b32 s28, s50
    s_and_b32 s29, s51, 0xffff
    s_mov_b32 s30, 0x800000
    s_mov_b32 s31, 0x20000
    s_lshl_b32 s73, s3, 13
    v_add_u32 v8, s73, v2
    v_add_u32 v9, 0x10000, v8
    v_lshlrev_b32 v10, 4, v6
    v_lshl_add_u32 v10, v5, 9, v10
    v_bfe_u32 v84, v0, 4, 1
    v_lshl_add_u32 v10, v84, 11, v10
    s_lshl_b32 s73, s3, 15
    v_add_u32 v10, s73, v10
    s_branch L_fl1_back
L_x3:
    s_cmp_lg_u32 s60, 0
    s_cbranch_scc1 L_x3b
    s_lshl_b32 s72, s57, 6
    buffer_load_dwordx4 v[48:51], v11, s[8:11], s72 offen offset:0
    buffer_load_dwordx4 v[56:59], v11, s[12:15], s72 offen offset:0
    buffer_load_dwordx4 v[52:55], v11, s[8:11], s72 offen offset:32
    buffer_load_dwordx4 v[60:63], v11, s[12:15], s72 offen offset:32
    s_mov_b32 s72, 0x80000000
    buffer_load_dword v16, v14, s[4:7], s72 offen
    buffer_load_dword v16, v14, s[4:7], s72 offen
    buffer_load_dword v16, v14, s[4:7], s72 offen
    s_cmp_eq_u32 s87, 0
    s_cbranch_scc1 L_x3c
    s_add_u32 m0, s95, 0
    s_nop 0
    buffer_load_dwordx4 v64, s[20:23], s68 offen lds
    s_add_u32 m0, s95, 1024
    s_nop 0
    buffer_load_dwordx4 v65, s[20:23], s68 offen lds
    s_add_u32 m0, s95, 2048
    s_nop 0
    buffer_load_dwordx4 v66, s[20:23], s68 offen lds
    s_add_u32 m0, s95, 3072
    s_nop 0
    buffer_load_dwordx4 v67, s[20:23], s68 offen lds
    s_add_u32 m0, s95, 4096
    s_nop 0
    buffer_load_dwordx4 v68, s[20:23], s68 offen lds
    s_add_u32 m0, s95, 5120
    s_nop 0
    buffer_load_dwordx4 v69, s[20:23], s68 offen lds
    s_add_u32 m0, s95, 6144
    s_nop 0
    buffer_load_dwordx4 v70, s[20:23], s68 offen lds
    s_add_u32 m0, s95, 7168
    s_nop 0
    buffer_load_dwordx4 v71, s[20:23], s68 offen lds
    s_add_u32 m0, s95, 8192
    s_nop 0
    buffer_load_dwordx4 v72, s[20:23], s68 offen lds
    s_branch L_x3_back
L_x3c:
    buffer_load_dword v16, v14, s[4:7], s72 offen
    buffer_load_dword v16, v14, s[4:7], s72 offen
    buffer_load_dword v16, v14, s[4:7], s72 offen
    buffer_load_dword v16, v14, s[4:7], s72 offen
    buffer_load_dword v16, v14, s[4:7], s72 offen
    buffer_load_dword v16, v14, s[4:7], s72 offen
    buffer_load_dword v16, v14, s[4:7], s72 offen
    buffer_load_dword v16, v14, s[4:7], s72 offen
    buffer_load_dword v16, v14, s[4:7], s72 offen
    s_branch L_x3_back
L_x3b:
    s_add_u32 s73, s67, 0
    buffer_load_dwordx2 v[16:17], v7, s[16:19], s73 offen
    s_add_u32 s73, s67, 8192
    buffer_load_dwordx2 v[18:19], v7, s[16:19], s73 offen
    s_add_u32 s73, s67, 16384
    buffer_load_dwordx2 v[20:21], v7, s[16:19], s73 offen
    s_add_u32 s73, s67, 24576
    buffer_load_dwordx2 v[22:23], v7, s[16:19], s73 offen
    s_add_u32 s73, s67, 32768
    buffer_load_dwordx2 v[24:25], v7, s[16:19], s73 offen
    s_add_u32 s73, s67, 40960
    buffer_load_dwordx2 v[26:27], v7, s[16:19], s73 offen
    s_add_u32 s73, s67, 49152
    buffer_load_dwordx2 v[28:29], v7, s[16:19], s73 offen
    s_add_u32 s73, s67, 57344
    buffer_load_dwordx2 v[30:31], v7, s[16:19], s73 offen
    s_add_u32 s73, s67, 131072
    buffer_load_dwordx2 v[32:33], v7, s[16:19], s73 offen
    s_add_u32 s73, s67, 139264
    buffer_load_dwordx2 v[34:35], v7, s[16:19], s73 offen
    s_add_u32 s73, s67, 147456
    buffer_load_dwordx2 v[36:37], v7, s[16:19], s73 offen
    s_add_u32 s73, s67, 155648
    buffer_load_dwordx2 v[38:39], v7, s[16:19], s73 offen
    s_add_u32 s73, s67, 163840
    buffer_load_dwordx2 v[40:41], v7, s[16:19], s73 offen
    s_add_u32 s73, s67, 172032
    buffer_load_dwordx2 v[42:43], v7, s[16:19], s73 offen
    s_add_u32 s73, s67, 180224
    buffer_load_dwordx2 v[44:45], v7, s[16:19], s73 offen
    s_add_u32 s73, s67, 188416
    buffer_load_dwordx2 v[46:47], v7, s[16:19], s73 offen
    s_branch L_x3_back
L_codeend:
    s_endpgm
.section .rodata,"a"
.p2align 6
.amdhsa_kernel standalone__adm_resblock__diffusion_kernel
  .amdhsa_next_free_vgpr 448
  .amdhsa_next_free_sgpr 102
  .amdhsa_accum_offset 256
  .amdhsa_group_segment_fixed_size 0
  .amdhsa_kernarg_size 96
  .amdhsa_user_sgpr_count 2
  .amdhsa_user_sgpr_kernarg_segment_ptr 1
  .amdhsa_system_sgpr_workgroup_id_x 1
  .amdhsa_float_denorm_mode_32 3
.end_amdhsa_kernel
```
